```python
import torch

def _softmax(x, axis=-1):
    return torch.softmax(x, dim=axis)

def _gelu(x):
    return torch.nn.functional.gelu(x, approximate='tanh')

def _silu(x):
    return torch.nn.functional.silu(x)

def _sigmoid(x):
    return torch.sigmoid(x)

def _layernorm(x, axis=-1, eps=1e-05):
    m = x.mean(dim=axis, keepdim=True)
    v = x.var(dim=axis, keepdim=True, unbiased=False)
    return (x - m) / torch.sqrt(v + eps)

def _scatter_add(tgt, idx, src, axis=0):
    return tgt.clone().index_add_(axis, idx, src)

def _segment_sum(src, seg, n):
    out = torch.zeros((n,) + src.shape[1:], dtype=src.dtype)
    return out.index_add_(0, seg, src)

def _pad(x, pw):
    flat = tuple((v for pair in reversed(pw) for v in pair))
    return torch.nn.functional.pad(x, flat)
kernel_name = 'adaLN_cond__gqa_block_cached__dense_activation_silu__decode'

def setup_inputs():

    _w = lambda a: (lambda t: t.to(torch.bfloat16) if t.is_floating_point() else t)(torch.as_tensor(a))

    def _A_setup():
        B, Sq, D = (2, 1, 512)
        Hq, Hkv, Sk, Dh = (32, 8, 32768, 128)
        assert Hq % Hkv == 0, (Hq, Hkv)
        return {'x': _w((lambda *s: torch.randn(*s, dtype=torch.bfloat16) * 0.1)(B, Sq, D)), 'k_cache': _w((lambda *s: torch.randn(*s, dtype=torch.bfloat16) * 0.8)(B, Hkv, Sk, Dh)), 'v_cache': _w((lambda *s: torch.randn(*s, dtype=torch.bfloat16) * 3.2)(B, Hkv, Sk, Dh)), 'wq': _w((lambda *s: torch.randn(*s, dtype=torch.bfloat16) * 0.8)(D, Hq * Dh) * D ** (-0.5)), 'wo': _w((lambda *s: torch.randn(*s, dtype=torch.bfloat16) * 3.2)(Hq * Dh, D) * (Hq * Dh) ** (-0.5))}
    _A_in = _A_setup()

    def _B_setup():
        B, S, D, F = (2, 1, 512, 1792)
        return {'x': _w((lambda *s: torch.randn(*s, dtype=torch.bfloat16) * 0.1)(B, S, D)), 'w1': _w((lambda *s: torch.randn(*s, dtype=torch.bfloat16) * 3.2)(D, F) * D ** (-0.5)), 'w2': _w((lambda *s: torch.randn(*s, dtype=torch.bfloat16) * 3.2)(F, D) * F ** (-0.5))}
    _B_in = _B_setup()
    return {'A_x': _A_in['x'], 'A_k_cache': _A_in['k_cache'], 'A_v_cache': _A_in['v_cache'], 'A_wq': _A_in['wq'], 'A_wo': _A_in['wo'], 'B_x': _B_in['x'], 'B_w1': _B_in['w1'], 'B_w2': _B_in['w2'], 'c': _w((lambda *s: torch.randn(*s, dtype=torch.bfloat16) * 0.4)(2, 512) * 8.0), 'w_mod': _w((lambda *s: torch.randn(*s, dtype=torch.bfloat16) * 0.4)(512, 6 * 512) * 512 ** (-0.5) * 8.0)}

def reference(A_x, A_k_cache, A_v_cache, A_wq, A_wo, B_x, B_w1, B_w2, c, w_mod):

    def _A_ref(x, k_cache, v_cache, wq, wo):
        B, Sq, D = x.shape
        Hq, Dh = (32, 128)
        Hkv = k_cache.shape[1]
        rep = Hq // Hkv
        q = (lambda x, *d: x.permute(*d))((x @ wq).reshape(B, Sq, Hq, Dh), 0, 2, 1, 3)
        k = (lambda x, n, axis: torch.repeat_interleave(x, n, dim=axis))(k_cache, rep, axis=1)
        v = (lambda x, n, axis: torch.repeat_interleave(x, n, dim=axis))(v_cache, rep, axis=1)
        scores = torch.einsum('bhqd,bhkd->bhqk', q, k) * Dh ** (-0.5)
        p = _softmax(scores, axis=-1)
        o = torch.einsum('bhqk,bhkd->bhqd', p, v)
        return (lambda x, *d: x.permute(*d))(o, 0, 2, 1, 3).reshape(B, Sq, Hq * Dh) @ wo

    def _B_ref(x, w1, w2):
        h = torch.einsum('bsd,df->bsf', x, w1)
        h = _silu(h)
        out = torch.einsum('bsf,fd->bsd', h, w2)
        return out
    x = A_x
    mod = (_silu(c) @ w_mod).reshape(c.shape[0], 6, 1, -1)
    sa, ca, ga, sb, cb, gb = (mod[:, 0].clone(), mod[:, 1].clone(), mod[:, 2].clone(), mod[:, 3].clone(), mod[:, 4].clone(), mod[:, 5].clone())
    h = _layernorm(x, axis=-1) * (1 + ca) + sa
    x = x + ga * _A_ref(h, A_k_cache, A_v_cache, A_wq, A_wo)
    h = _layernorm(x, axis=-1) * (1 + cb) + sb
    x = x + gb * _B_ref(h, B_w1, B_w2)
    return x
```

```asm
; @launch grid=(256,1,1) block=(512,1,1) lds=151552
.amdgcn_target "amdgcn-amd-amdhsa--gfx950"
.text
.globl adaLN_cond__gqa_block_cached__dense_activation_silu__decode_kernel
.p2align 8
.type adaLN_cond__gqa_block_cached__dense_activation_silu__decode_kernel,@function
adaLN_cond__gqa_block_cached__dense_activation_silu__decode_kernel:
  s_cmp_ge_u32 s2, 256
  s_cbranch_scc1 L_end
  s_load_dwordx16 s[16:31], s[0:1], 0
  s_load_dwordx8 s[32:39], s[0:1], 64
  s_load_dwordx2 s[40:41], s[0:1], 96
  v_and_b32 v1, 63, v0
  v_lshrrev_b32 v2, 6, v0
  s_mov_b32 s60, 0xaaaaaaaa
  s_mov_b32 s61, 0xaaaaaaaa
  v_readfirstlane_b32 s3, v2
  s_mov_b32 s62, 0xcccccccc
  s_mov_b32 s63, 0xcccccccc
  s_mov_b32 s64, 0
  s_mov_b32 s65, -1
  s_mov_b32 s46, 4194304
  s_mov_b32 s47, 0x20000
  s_mov_b32 s50, 256
  s_mov_b32 s51, 0x20000
  s_mov_b32 s42, 400000
  s_cmp_lt_u32 s2, 64
  s_cbranch_scc1 L_role
  s_sub_u32 s4, s2, 64
  s_lshr_b32 s6, s4, 4
  s_add_u32 s5, s4, s6
  s_and_b32 s5, s5, 15
  s_mul_i32 s9, s6, 65536
  s_lshr_b32 s9, s9, 16
  s_mul_i32 s10, s9, 1
  s_sub_u32 s10, s6, s10
  s_lshr_b32 s7, s3, 2
  s_mul_i32 s7, s7, 12
  s_add_u32 s7, s7, s9
  s_mul_i32 s8, s7, 344064
  s_and_b32 s7, s3, 3
  s_lshl_b32 s10, s10, 2
  s_add_u32 s7, s7, s10
  s_lshl_b32 s7, s7, 12
  s_add_u32 s8, s8, s7
  s_lshl_b32 s11, s5, 23
  s_add_u32 s8, s8, s11
  v_and_b32 v9, 1, v1
  v_lshlrev_b32 v2, 4, v9
  v_lshrrev_b32 v10, 4, v1
  v_lshl_add_u32 v2, v10, 5, v2
  v_bfe_u32 v11, v1, 1, 1
  v_lshl_add_u32 v2, v11, 10, v2
  v_bfe_u32 v11, v1, 2, 2
  v_lshl_add_u32 v2, v11, 8, v2
  v_lshlrev_b32 v3, 4, v1
  s_mov_b32 s54, 315392
  s_mov_b32 s55, 0x20000
  s_mov_b32 s14, 315392
  s_mov_b32 s15, 0x20000
  v_mov_b32 v12, 1024
  v_mov_b32 v7, 0
  ds_write2_b32 v12, v7, v7 offset0:0 offset1:1
  ds_write2_b32 v12, v7, v7 offset0:2 offset1:3
  s_mul_i32 s43, s5, 1536
  s_add_u32 s43, s43, 131072
  s_waitcnt lgkmcnt(0)
  s_add_u32 s52, s18, s8
  s_addc_u32 s53, s19, 0
  s_add_u32 s12, s20, s8
  s_addc_u32 s13, s21, 0
  s_mov_b32 s44, s40
  s_mov_b32 s45, s41
  s_mov_b32 s48, s38
  s_mov_b32 s49, s39
  s_mul_i32 s58, s3, 16384
  s_add_u32 s58, s58, 20480
  v_add_u32 v13, s58, v3
  s_mov_b32 s56, 0
  buffer_load_dwordx4 v[96:99], v2, s[52:55], s56 offen offset:0 nt
  buffer_load_dwordx4 v[100:103], v2, s[52:55], s56 offen offset:128 nt
  buffer_load_dwordx4 v[104:107], v2, s[52:55], s56 offen offset:2048 nt
  buffer_load_dwordx4 v[108:111], v2, s[52:55], s56 offen offset:2176 nt
  s_barrier
  s_mov_b32 s56, 16384
  buffer_load_dwordx4 v[112:115], v2, s[52:55], s56 offen offset:0 nt
  buffer_load_dwordx4 v[116:119], v2, s[52:55], s56 offen offset:128 nt
  buffer_load_dwordx4 v[120:123], v2, s[52:55], s56 offen offset:2048 nt
  buffer_load_dwordx4 v[124:127], v2, s[52:55], s56 offen offset:2176 nt
  s_mov_b32 s56, 32768
  buffer_load_dwordx4 v[128:131], v2, s[52:55], s56 offen offset:0 nt
  buffer_load_dwordx4 v[132:135], v2, s[52:55], s56 offen offset:128 nt
  buffer_load_dwordx4 v[136:139], v2, s[52:55], s56 offen offset:2048 nt
  buffer_load_dwordx4 v[140:143], v2, s[52:55], s56 offen offset:2176 nt
  s_mov_b32 s56, 49152
  buffer_load_dwordx4 v[144:147], v2, s[52:55], s56 offen offset:0 nt
  buffer_load_dwordx4 v[148:151], v2, s[52:55], s56 offen offset:128 nt
  buffer_load_dwordx4 v[152:155], v2, s[52:55], s56 offen offset:2048 nt
  buffer_load_dwordx4 v[156:159], v2, s[52:55], s56 offen offset:2176 nt
  s_mov_b32 s56, 65536
  buffer_load_dwordx4 v[160:163], v2, s[52:55], s56 offen offset:0 nt
  buffer_load_dwordx4 v[164:167], v2, s[52:55], s56 offen offset:128 nt
  buffer_load_dwordx4 v[168:171], v2, s[52:55], s56 offen offset:2048 nt
  buffer_load_dwordx4 v[172:175], v2, s[52:55], s56 offen offset:2176 nt
  s_mov_b32 s56, 81920
  buffer_load_dwordx4 v[176:179], v2, s[52:55], s56 offen offset:0 nt
  buffer_load_dwordx4 v[180:183], v2, s[52:55], s56 offen offset:128 nt
  buffer_load_dwordx4 v[184:187], v2, s[52:55], s56 offen offset:2048 nt
  buffer_load_dwordx4 v[188:191], v2, s[52:55], s56 offen offset:2176 nt
  s_mov_b32 s56, 98304
  buffer_load_dwordx4 v[192:195], v2, s[52:55], s56 offen offset:0 nt
  buffer_load_dwordx4 v[196:199], v2, s[52:55], s56 offen offset:128 nt
  buffer_load_dwordx4 v[200:203], v2, s[52:55], s56 offen offset:2048 nt
  buffer_load_dwordx4 v[204:207], v2, s[52:55], s56 offen offset:2176 nt
  s_mov_b32 s56, 114688
  buffer_load_dwordx4 v[208:211], v2, s[52:55], s56 offen offset:0 nt
  buffer_load_dwordx4 v[212:215], v2, s[52:55], s56 offen offset:128 nt
  buffer_load_dwordx4 v[216:219], v2, s[52:55], s56 offen offset:2048 nt
  buffer_load_dwordx4 v[220:223], v2, s[52:55], s56 offen offset:2176 nt
  s_mov_b32 s56, 131072
  buffer_load_dwordx4 v[224:227], v2, s[52:55], s56 offen offset:0 nt
  buffer_load_dwordx4 v[228:231], v2, s[52:55], s56 offen offset:128 nt
  buffer_load_dwordx4 v[232:235], v2, s[52:55], s56 offen offset:2048 nt
  buffer_load_dwordx4 v[236:239], v2, s[52:55], s56 offen offset:2176 nt
  s_mov_b32 s56, 147456
  buffer_load_dwordx4 v[240:243], v2, s[52:55], s56 offen offset:0 nt
  buffer_load_dwordx4 v[244:247], v2, s[52:55], s56 offen offset:128 nt
  buffer_load_dwordx4 v[248:251], v2, s[52:55], s56 offen offset:2048 nt
  buffer_load_dwordx4 v[252:255], v2, s[52:55], s56 offen offset:2176 nt
  s_mov_b32 s56, 163840
  buffer_load_dwordx4 v[40:43], v2, s[52:55], s56 offen offset:0 nt
  buffer_load_dwordx4 v[44:47], v2, s[52:55], s56 offen offset:128 nt
  buffer_load_dwordx4 v[48:51], v2, s[52:55], s56 offen offset:2048 nt
  buffer_load_dwordx4 v[52:55], v2, s[52:55], s56 offen offset:2176 nt
  s_mov_b32 s56, 180224
  buffer_load_dwordx4 v[56:59], v2, s[52:55], s56 offen offset:0 nt
  buffer_load_dwordx4 v[60:63], v2, s[52:55], s56 offen offset:128 nt
  buffer_load_dwordx4 v[80:83], v2, s[52:55], s56 offen offset:2048 nt
  buffer_load_dwordx4 v[84:87], v2, s[52:55], s56 offen offset:2176 nt
  s_mov_b32 s56, 196608
  s_add_u32 m0, s58, 0
  s_nop 0
  buffer_load_dwordx4 v2, s[52:55], s56 offen offset:0 nt lds
  s_add_u32 m0, s58, 896
  s_nop 0
  buffer_load_dwordx4 v2, s[52:55], s56 offen offset:128 nt lds
  s_add_u32 m0, s58, 0
  s_nop 0
  buffer_load_dwordx4 v2, s[52:55], s56 offen offset:2048 nt lds
  s_add_u32 m0, s58, 896
  s_nop 0
  buffer_load_dwordx4 v2, s[52:55], s56 offen offset:2176 nt lds
  s_mov_b32 s56, 212992
  s_add_u32 m0, s58, 4096
  s_nop 0
  buffer_load_dwordx4 v2, s[52:55], s56 offen offset:0 nt lds
  s_add_u32 m0, s58, 4992
  s_nop 0
  buffer_load_dwordx4 v2, s[52:55], s56 offen offset:128 nt lds
  s_add_u32 m0, s58, 4096
  s_nop 0
  buffer_load_dwordx4 v2, s[52:55], s56 offen offset:2048 nt lds
  s_add_u32 m0, s58, 4992
  s_nop 0
  buffer_load_dwordx4 v2, s[52:55], s56 offen offset:2176 nt lds
  s_mov_b32 s56, 229376
  s_add_u32 m0, s58, 8192
  s_nop 0
  buffer_load_dwordx4 v2, s[52:55], s56 offen offset:0 nt lds
  s_add_u32 m0, s58, 9088
  s_nop 0
  buffer_load_dwordx4 v2, s[52:55], s56 offen offset:128 nt lds
  s_add_u32 m0, s58, 8192
  s_nop 0
  buffer_load_dwordx4 v2, s[52:55], s56 offen offset:2048 nt lds
  s_add_u32 m0, s58, 9088
  s_nop 0
  buffer_load_dwordx4 v2, s[52:55], s56 offen offset:2176 nt lds
  s_mov_b32 s56, 245760
  s_add_u32 m0, s58, 12288
  s_nop 0
  buffer_load_dwordx4 v2, s[52:55], s56 offen offset:0 nt lds
  s_add_u32 m0, s58, 13184
  s_nop 0
  buffer_load_dwordx4 v2, s[52:55], s56 offen offset:128 nt lds
  s_add_u32 m0, s58, 12288
  s_nop 0
  buffer_load_dwordx4 v2, s[52:55], s56 offen offset:2048 nt lds
  s_add_u32 m0, s58, 13184
  s_nop 0
  buffer_load_dwordx4 v2, s[52:55], s56 offen offset:2176 nt lds
  v_mov_b32 v10, 0xffff
  v_mov_b32 v11, 0xffff0000
  v_cndmask_b32 v10, v10, v11, s[60:61]
  v_cndmask_b32 v4, v10, 0, s[62:63]
  v_cndmask_b32 v5, 0, v10, s[62:63]
  v_mov_b32 v6, 0xff800000
  v_bfe_u32 v9, v1, 2, 2
  v_lshlrev_b32 v9, 8, v9
  v_lshrrev_b32 v10, 4, v1
  v_lshl_add_u32 v9, v10, 5, v9
  v_and_b32 v10, 1, v1
  v_lshl_add_u32 v9, v10, 4, v9
  s_setprio 0
  s_cmp_lg_u32 s3, 0
  s_cbranch_scc1 Lnoq_1
  s_setprio 3
  s_lshl_b32 s57, s5, 11
  s_add_u32 s57, s57, 32768
  v_lshlrev_b32 v11, 5, v1
  s_mov_b32 s58, s42
  s_mov_b64 s[74:75], -1
Lpoll_2:
  buffer_load_dword v8, v7, s[48:51], 0 offen sc1
  buffer_load_dwordx4 v[88:91], v11, s[44:47], s57 offen sc1
  buffer_load_dwordx4 v[92:95], v11, s[44:47], s57 offen offset:16 sc1
  s_waitcnt vmcnt(0)
  v_cmpx_ne_u32 vcc, 0, v8
  v_cmpx_eq_u32 vcc, v89, v8
  v_cmpx_eq_u32 vcc, v91, v8
  v_cmpx_eq_u32 vcc, v93, v8
  v_cmpx_eq_u32 vcc, v95, v8
  s_nop 0
  s_andn2_b64 s[74:75], s[74:75], exec
  s_cbranch_scc0 Lpdone_3
  s_mov_b64 exec, s[74:75]
  s_sleep 2
  s_sub_u32 s58, s58, 1
  s_cbranch_scc0 Lpoll_2
Lpdone_3:
  s_mov_b64 exec, -1
  s_nop 1
  v_mov_b32 v89, v90
  v_mov_b32 v90, v92
  v_mov_b32 v91, v94
  v_or_b32 v8, 1, v8
  ds_write_b128 v3, v[88:91]
  s_waitcnt lgkmcnt(0)
  ds_write_b32 v12, v8
  s_setprio 0
Lnoq_1:
Lqwait_4:
  ds_read_b32 v8, v12
  ds_read_b128 v[88:91], v9
  ds_read_b128 v[92:95], v9 offset:128
  s_waitcnt lgkmcnt(0)
  v_cmp_eq_u32 vcc, 0, v8
  s_nop 0
  s_cmp_eq_u64 vcc, 0
  s_cbranch_scc1 Lqgo_5
  s_sleep 2
  s_branch Lqwait_4
Lqgo_5:
  v_cndmask_b32 v16, v88, 0, s[62:63]
  v_cndmask_b32 v24, 0, v88, s[62:63]
  v_cndmask_b32 v17, v89, 0, s[62:63]
  v_cndmask_b32 v25, 0, v89, s[62:63]
  v_cndmask_b32 v18, v90, 0, s[62:63]
  v_cndmask_b32 v26, 0, v90, s[62:63]
  v_cndmask_b32 v19, v91, 0, s[62:63]
  v_cndmask_b32 v27, 0, v91, s[62:63]
  v_cndmask_b32 v20, v92, 0, s[62:63]
  v_cndmask_b32 v28, 0, v92, s[62:63]
  v_cndmask_b32 v21, v93, 0, s[62:63]
  v_cndmask_b32 v29, 0, v93, s[62:63]
  v_cndmask_b32 v22, v94, 0, s[62:63]
  v_cndmask_b32 v30, 0, v94, s[62:63]
  v_cndmask_b32 v23, v95, 0, s[62:63]
  v_cndmask_b32 v31, 0, v95, s[62:63]
  s_mov_b32 s57, 1035273459
  s_waitcnt vmcnt(60)
  v_mfma_f32_16x16x32_bf16 v[32:35], v[96:99], v[16:19], 0
  v_mfma_f32_16x16x32_bf16 v[32:35], v[100:103], v[20:23], v[32:35]
  v_mfma_f32_16x16x32_bf16 v[32:35], v[104:107], v[24:27], v[32:35]
  v_mfma_f32_16x16x32_bf16 v[32:35], v[108:111], v[28:31], v[32:35]
  s_mov_b32 s56, 262144
  buffer_load_dwordx4 v[96:99], v2, s[52:55], s56 offen offset:0 nt
  buffer_load_dwordx4 v[100:103], v2, s[52:55], s56 offen offset:128 nt
  buffer_load_dwordx4 v[104:107], v2, s[52:55], s56 offen offset:2048 nt
  buffer_load_dwordx4 v[108:111], v2, s[52:55], s56 offen offset:2176 nt
  s_waitcnt vmcnt(60)
  v_mfma_f32_16x16x32_bf16 v[36:39], v[112:115], v[16:19], 0
  v_mfma_f32_16x16x32_bf16 v[36:39], v[116:119], v[20:23], v[36:39]
  v_mfma_f32_16x16x32_bf16 v[36:39], v[120:123], v[24:27], v[36:39]
  v_mfma_f32_16x16x32_bf16 v[36:39], v[124:127], v[28:31], v[36:39]
  s_mov_b32 s56, 278528
  buffer_load_dwordx4 v[112:115], v2, s[52:55], s56 offen offset:0 nt
  buffer_load_dwordx4 v[116:119], v2, s[52:55], s56 offen offset:128 nt
  buffer_load_dwordx4 v[120:123], v2, s[52:55], s56 offen offset:2048 nt
  buffer_load_dwordx4 v[124:127], v2, s[52:55], s56 offen offset:2176 nt
  v_add_f32_dpp v9, v33, v32 quad_perm:[1,0,3,2] row_mask:0xf bank_mask:0xf
  v_add_f32_dpp v10, v34, v35 quad_perm:[1,0,3,2] row_mask:0xf bank_mask:0xf
  v_cndmask_b32 v66, v9, v10, s[60:61]
  s_waitcnt vmcnt(60)
  v_mfma_f32_16x16x32_bf16 v[32:35], v[128:131], v[16:19], 0
  v_mfma_f32_16x16x32_bf16 v[32:35], v[132:135], v[20:23], v[32:35]
  v_mfma_f32_16x16x32_bf16 v[32:35], v[136:139], v[24:27], v[32:35]
  v_mfma_f32_16x16x32_bf16 v[32:35], v[140:143], v[28:31], v[32:35]
  s_mov_b32 s56, 294912
  buffer_load_dwordx4 v[128:131], v2, s[52:55], s56 offen offset:0 nt
  buffer_load_dwordx4 v[132:135], v2, s[52:55], s56 offen offset:128 nt
  buffer_load_dwordx4 v[136:139], v2, s[52:55], s56 offen offset:2048 nt
  buffer_load_dwordx4 v[140:143], v2, s[52:55], s56 offen offset:2176 nt
  v_add_f32_dpp v9, v37, v36 quad_perm:[1,0,3,2] row_mask:0xf bank_mask:0xf
  v_add_f32_dpp v10, v38, v39 quad_perm:[1,0,3,2] row_mask:0xf bank_mask:0xf
  v_cndmask_b32 v67, v9, v10, s[60:61]
  v_cvt_pk_bf16_f32 v11, v66, v67
  v_lshlrev_b32 v66, 16, v11
  v_and_b32 v67, 0xffff0000, v11
  v_mul_f32 v66, s57, v66
  v_mul_f32 v67, s57, v67
  v_cvt_pk_bf16_f32 v11, v66, v67
  v_lshlrev_b32 v66, 16, v11
  v_and_b32 v67, 0xffff0000, v11
  v_max3_f32 v6, v6, v66, v67
  s_waitcnt vmcnt(60)
  v_mfma_f32_16x16x32_bf16 v[36:39], v[144:147], v[16:19], 0
  v_mfma_f32_16x16x32_bf16 v[36:39], v[148:151], v[20:23], v[36:39]
  v_mfma_f32_16x16x32_bf16 v[36:39], v[152:155], v[24:27], v[36:39]
  v_mfma_f32_16x16x32_bf16 v[36:39], v[156:159], v[28:31], v[36:39]
  s_mov_b32 s56, 311296
  buffer_load_dwordx4 v[144:147], v2, s[52:55], s56 offen offset:0 nt
  buffer_load_dwordx4 v[148:151], v2, s[52:55], s56 offen offset:128 nt
  buffer_load_dwordx4 v[152:155], v2, s[52:55], s56 offen offset:2048 nt
  buffer_load_dwordx4 v[156:159], v2, s[52:55], s56 offen offset:2176 nt
  v_add_f32_dpp v9, v33, v32 quad_perm:[1,0,3,2] row_mask:0xf bank_mask:0xf
  v_add_f32_dpp v10, v34, v35 quad_perm:[1,0,3,2] row_mask:0xf bank_mask:0xf
  v_cndmask_b32 v68, v9, v10, s[60:61]
  s_waitcnt vmcnt(60)
  v_mfma_f32_16x16x32_bf16 v[32:35], v[160:163], v[16:19], 0
  v_mfma_f32_16x16x32_bf16 v[32:35], v[164:167], v[20:23], v[32:35]
  v_mfma_f32_16x16x32_bf16 v[32:35], v[168:171], v[24:27], v[32:35]
  v_mfma_f32_16x16x32_bf16 v[32:35], v[172:175], v[28:31], v[32:35]
  s_mov_b32 s56, 0
  buffer_load_dwordx4 v[160:163], v3, s[12:15], s56 offen offset:0 nt
  s_cmp_lg_u32 s3, 7
  s_cbranch_scc1 Lnostamp_6
  ds_write_b32 v12, v8 offset:8
Lnostamp_6:
  buffer_load_dwordx4 v[164:167], v3, s[12:15], s56 offen offset:1024 nt
  buffer_load_dwordx4 v[168:171], v3, s[12:15], s56 offen offset:2048 nt
  buffer_load_dwordx4 v[172:175], v3, s[12:15], s56 offen offset:3072 nt
  v_add_f32_dpp v9, v37, v36 quad_perm:[1,0,3,2] row_mask:0xf bank_mask:0xf
  v_add_f32_dpp v10, v38, v39 quad_perm:[1,0,3,2] row_mask:0xf bank_mask:0xf
  v_cndmask_b32 v69, v9, v10, s[60:61]
  v_cvt_pk_bf16_f32 v11, v68, v69
  v_lshlrev_b32 v68, 16, v11
  v_and_b32 v69, 0xffff0000, v11
  v_mul_f32 v68, s57, v68
  v_mul_f32 v69, s57, v69
  v_cvt_pk_bf16_f32 v11, v68, v69
  v_lshlrev_b32 v68, 16, v11
  v_and_b32 v69, 0xffff0000, v11
  v_max3_f32 v6, v6, v68, v69
  s_waitcnt vmcnt(60)
  v_mfma_f32_16x16x32_bf16 v[36:39], v[176:179], v[16:19], 0
  v_mfma_f32_16x16x32_bf16 v[36:39], v[180:183], v[20:23], v[36:39]
  v_mfma_f32_16x16x32_bf16 v[36:39], v[184:187], v[24:27], v[36:39]
  v_mfma_f32_16x16x32_bf16 v[36:39], v[188:191], v[28:31], v[36:39]
  s_mov_b32 s56, 16384
  buffer_load_dwordx4 v[176:179], v3, s[12:15], s56 offen offset:0 nt
  buffer_load_dwordx4 v[180:183], v3, s[12:15], s56 offen offset:1024 nt
  buffer_load_dwordx4 v[184:187], v3, s[12:15], s56 offen offset:2048 nt
  buffer_load_dwordx4 v[188:191], v3, s[12:15], s56 offen offset:3072 nt
  v_add_f32_dpp v9, v33, v32 quad_perm:[1,0,3,2] row_mask:0xf bank_mask:0xf
  v_add_f32_dpp v10, v34, v35 quad_perm:[1,0,3,2] row_mask:0xf bank_mask:0xf
  v_cndmask_b32 v70, v9, v10, s[60:61]
  s_waitcnt vmcnt(60)
  v_mfma_f32_16x16x32_bf16 v[32:35], v[192:195], v[16:19], 0
  v_mfma_f32_16x16x32_bf16 v[32:35], v[196:199], v[20:23], v[32:35]
  v_mfma_f32_16x16x32_bf16 v[32:35], v[200:203], v[24:27], v[32:35]
  v_mfma_f32_16x16x32_bf16 v[32:35], v[204:207], v[28:31], v[32:35]
  s_mov_b32 s56, 32768
  buffer_load_dwordx4 v[192:195], v3, s[12:15], s56 offen offset:0 nt
  buffer_load_dwordx4 v[196:199], v3, s[12:15], s56 offen offset:1024 nt
  buffer_load_dwordx4 v[200:203], v3, s[12:15], s56 offen offset:2048 nt
  buffer_load_dwordx4 v[204:207], v3, s[12:15], s56 offen offset:3072 nt
  v_add_f32_dpp v9, v37, v36 quad_perm:[1,0,3,2] row_mask:0xf bank_mask:0xf
  v_add_f32_dpp v10, v38, v39 quad_perm:[1,0,3,2] row_mask:0xf bank_mask:0xf
  v_cndmask_b32 v71, v9, v10, s[60:61]
  v_cvt_pk_bf16_f32 v11, v70, v71
  v_lshlrev_b32 v70, 16, v11
  v_and_b32 v71, 0xffff0000, v11
  v_mul_f32 v70, s57, v70
  v_mul_f32 v71, s57, v71
  v_cvt_pk_bf16_f32 v11, v70, v71
  v_lshlrev_b32 v70, 16, v11
  v_and_b32 v71, 0xffff0000, v11
  v_max3_f32 v6, v6, v70, v71
  s_waitcnt vmcnt(60)
  v_mfma_f32_16x16x32_bf16 v[36:39], v[208:211], v[16:19], 0
  v_mfma_f32_16x16x32_bf16 v[36:39], v[212:215], v[20:23], v[36:39]
  v_mfma_f32_16x16x32_bf16 v[36:39], v[216:219], v[24:27], v[36:39]
  v_mfma_f32_16x16x32_bf16 v[36:39], v[220:223], v[28:31], v[36:39]
  s_mov_b32 s56, 49152
  buffer_load_dwordx4 v[208:211], v3, s[12:15], s56 offen offset:0 nt
  buffer_load_dwordx4 v[212:215], v3, s[12:15], s56 offen offset:1024 nt
  buffer_load_dwordx4 v[216:219], v3, s[12:15], s56 offen offset:2048 nt
  buffer_load_dwordx4 v[220:223], v3, s[12:15], s56 offen offset:3072 nt
  v_add_f32_dpp v9, v33, v32 quad_perm:[1,0,3,2] row_mask:0xf bank_mask:0xf
  v_add_f32_dpp v10, v34, v35 quad_perm:[1,0,3,2] row_mask:0xf bank_mask:0xf
  v_cndmask_b32 v72, v9, v10, s[60:61]
  s_waitcnt vmcnt(60)
  v_mfma_f32_16x16x32_bf16 v[32:35], v[224:227], v[16:19], 0
  v_mfma_f32_16x16x32_bf16 v[32:35], v[228:231], v[20:23], v[32:35]
  v_mfma_f32_16x16x32_bf16 v[32:35], v[232:235], v[24:27], v[32:35]
  v_mfma_f32_16x16x32_bf16 v[32:35], v[236:239], v[28:31], v[32:35]
  s_mov_b32 s56, 65536
  buffer_load_dwordx4 v[224:227], v3, s[12:15], s56 offen offset:0 nt
  buffer_load_dwordx4 v[228:231], v3, s[12:15], s56 offen offset:1024 nt
  buffer_load_dwordx4 v[232:235], v3, s[12:15], s56 offen offset:2048 nt
  buffer_load_dwordx4 v[236:239], v3, s[12:15], s56 offen offset:3072 nt
  v_add_f32_dpp v9, v37, v36 quad_perm:[1,0,3,2] row_mask:0xf bank_mask:0xf
  v_add_f32_dpp v10, v38, v39 quad_perm:[1,0,3,2] row_mask:0xf bank_mask:0xf
  v_cndmask_b32 v73, v9, v10, s[60:61]
  v_cvt_pk_bf16_f32 v11, v72, v73
  v_lshlrev_b32 v72, 16, v11
  v_and_b32 v73, 0xffff0000, v11
  v_mul_f32 v72, s57, v72
  v_mul_f32 v73, s57, v73
  v_cvt_pk_bf16_f32 v11, v72, v73
  v_lshlrev_b32 v72, 16, v11
  v_and_b32 v73, 0xffff0000, v11
  v_max3_f32 v6, v6, v72, v73
  s_waitcnt vmcnt(60)
  v_mfma_f32_16x16x32_bf16 v[36:39], v[240:243], v[16:19], 0
  v_mfma_f32_16x16x32_bf16 v[36:39], v[244:247], v[20:23], v[36:39]
  v_mfma_f32_16x16x32_bf16 v[36:39], v[248:251], v[24:27], v[36:39]
  v_mfma_f32_16x16x32_bf16 v[36:39], v[252:255], v[28:31], v[36:39]
  s_mov_b32 s56, 81920
  buffer_load_dwordx4 v[240:243], v3, s[12:15], s56 offen offset:0 nt
  buffer_load_dwordx4 v[244:247], v3, s[12:15], s56 offen offset:1024 nt
  buffer_load_dwordx4 v[248:251], v3, s[12:15], s56 offen offset:2048 nt
  buffer_load_dwordx4 v[252:255], v3, s[12:15], s56 offen offset:3072 nt
  v_add_f32_dpp v9, v33, v32 quad_perm:[1,0,3,2] row_mask:0xf bank_mask:0xf
  v_add_f32_dpp v10, v34, v35 quad_perm:[1,0,3,2] row_mask:0xf bank_mask:0xf
  v_cndmask_b32 v74, v9, v10, s[60:61]
  s_waitcnt vmcnt(60)
  v_mfma_f32_16x16x32_bf16 v[32:35], v[40:43], v[16:19], 0
  v_mfma_f32_16x16x32_bf16 v[32:35], v[44:47], v[20:23], v[32:35]
  v_mfma_f32_16x16x32_bf16 v[32:35], v[48:51], v[24:27], v[32:35]
  v_mfma_f32_16x16x32_bf16 v[32:35], v[52:55], v[28:31], v[32:35]
  v_add_f32_dpp v9, v37, v36 quad_perm:[1,0,3,2] row_mask:0xf bank_mask:0xf
  v_add_f32_dpp v10, v38, v39 quad_perm:[1,0,3,2] row_mask:0xf bank_mask:0xf
  v_cndmask_b32 v75, v9, v10, s[60:61]
  v_cvt_pk_bf16_f32 v11, v74, v75
  v_lshlrev_b32 v74, 16, v11
  v_and_b32 v75, 0xffff0000, v11
  v_mul_f32 v74, s57, v74
  v_mul_f32 v75, s57, v75
  v_cvt_pk_bf16_f32 v11, v74, v75
  v_lshlrev_b32 v74, 16, v11
  v_and_b32 v75, 0xffff0000, v11
  v_max3_f32 v6, v6, v74, v75
  s_waitcnt vmcnt(56)
  v_mfma_f32_16x16x32_bf16 v[36:39], v[56:59], v[16:19], 0
  v_mfma_f32_16x16x32_bf16 v[36:39], v[60:63], v[20:23], v[36:39]
  v_mfma_f32_16x16x32_bf16 v[36:39], v[80:83], v[24:27], v[36:39]
  v_mfma_f32_16x16x32_bf16 v[36:39], v[84:87], v[28:31], v[36:39]
  v_add_f32_dpp v9, v33, v32 quad_perm:[1,0,3,2] row_mask:0xf bank_mask:0xf
  v_add_f32_dpp v10, v34, v35 quad_perm:[1,0,3,2] row_mask:0xf bank_mask:0xf
  v_cndmask_b32 v76, v9, v10, s[60:61]
  s_waitcnt vmcnt(52)
  ds_read_b128 v[40:43], v13 offset:0
  ds_read_b128 v[44:47], v13 offset:1024
  ds_read_b128 v[48:51], v13 offset:2048
  ds_read_b128 v[52:55], v13 offset:3072
  s_waitcnt lgkmcnt(0)
  v_mfma_f32_16x16x32_bf16 v[32:35], v[40:43], v[16:19], 0
  v_mfma_f32_16x16x32_bf16 v[32:35], v[44:47], v[20:23], v[32:35]
  v_mfma_f32_16x16x32_bf16 v[32:35], v[48:51], v[24:27], v[32:35]
  v_mfma_f32_16x16x32_bf16 v[32:35], v[52:55], v[28:31], v[32:35]
  v_add_f32_dpp v9, v37, v36 quad_perm:[1,0,3,2] row_mask:0xf bank_mask:0xf
  v_add_f32_dpp v10, v38, v39 quad_perm:[1,0,3,2] row_mask:0xf bank_mask:0xf
  v_cndmask_b32 v77, v9, v10, s[60:61]
  v_cvt_pk_bf16_f32 v11, v76, v77
  v_lshlrev_b32 v76, 16, v11
  v_and_b32 v77, 0xffff0000, v11
  v_mul_f32 v76, s57, v76
  v_mul_f32 v77, s57, v77
  v_cvt_pk_bf16_f32 v11, v76, v77
  v_lshlrev_b32 v76, 16, v11
  v_and_b32 v77, 0xffff0000, v11
  v_max3_f32 v6, v6, v76, v77
  s_waitcnt vmcnt(48)
  ds_read_b128 v[40:43], v13 offset:4096
  ds_read_b128 v[44:47], v13 offset:5120
  ds_read_b128 v[48:51], v13 offset:6144
  ds_read_b128 v[52:55], v13 offset:7168
  s_waitcnt lgkmcnt(0)
  v_mfma_f32_16x16x32_bf16 v[36:39], v[40:43], v[16:19], 0
  v_mfma_f32_16x16x32_bf16 v[36:39], v[44:47], v[20:23], v[36:39]
  v_mfma_f32_16x16x32_bf16 v[36:39], v[48:51], v[24:27], v[36:39]
  v_mfma_f32_16x16x32_bf16 v[36:39], v[52:55], v[28:31], v[36:39]
  v_add_f32_dpp v9, v33, v32 quad_perm:[1,0,3,2] row_mask:0xf bank_mask:0xf
  v_add_f32_dpp v10, v34, v35 quad_perm:[1,0,3,2] row_mask:0xf bank_mask:0xf
  v_cndmask_b32 v78, v9, v10, s[60:61]
  s_waitcnt vmcnt(44)
  ds_read_b128 v[40:43], v13 offset:8192
  ds_read_b128 v[44:47], v13 offset:9216
  ds_read_b128 v[48:51], v13 offset:10240
  ds_read_b128 v[52:55], v13 offset:11264
  s_waitcnt lgkmcnt(0)
  v_mfma_f32_16x16x32_bf16 v[32:35], v[40:43], v[16:19], 0
  v_mfma_f32_16x16x32_bf16 v[32:35], v[44:47], v[20:23], v[32:35]
  v_mfma_f32_16x16x32_bf16 v[32:35], v[48:51], v[24:27], v[32:35]
  v_mfma_f32_16x16x32_bf16 v[32:35], v[52:55], v[28:31], v[32:35]
  v_add_f32_dpp v9, v37, v36 quad_perm:[1,0,3,2] row_mask:0xf bank_mask:0xf
  v_add_f32_dpp v10, v38, v39 quad_perm:[1,0,3,2] row_mask:0xf bank_mask:0xf
  v_cndmask_b32 v79, v9, v10, s[60:61]
  v_cvt_pk_bf16_f32 v11, v78, v79
  v_lshlrev_b32 v78, 16, v11
  v_and_b32 v79, 0xffff0000, v11
  v_mul_f32 v78, s57, v78
  v_mul_f32 v79, s57, v79
  v_cvt_pk_bf16_f32 v11, v78, v79
  v_lshlrev_b32 v78, 16, v11
  v_and_b32 v79, 0xffff0000, v11
  v_max3_f32 v6, v6, v78, v79
  s_waitcnt vmcnt(40)
  ds_read_b128 v[40:43], v13 offset:12288
  ds_read_b128 v[44:47], v13 offset:13312
  ds_read_b128 v[48:51], v13 offset:14336
  ds_read_b128 v[52:55], v13 offset:15360
  s_waitcnt lgkmcnt(0)
  v_mfma_f32_16x16x32_bf16 v[36:39], v[40:43], v[16:19], 0
  v_mfma_f32_16x16x32_bf16 v[36:39], v[44:47], v[20:23], v[36:39]
  v_mfma_f32_16x16x32_bf16 v[36:39], v[48:51], v[24:27], v[36:39]
  v_mfma_f32_16x16x32_bf16 v[36:39], v[52:55], v[28:31], v[36:39]
  v_add_f32_dpp v9, v33, v32 quad_perm:[1,0,3,2] row_mask:0xf bank_mask:0xf
  v_add_f32_dpp v10, v34, v35 quad_perm:[1,0,3,2] row_mask:0xf bank_mask:0xf
  v_cndmask_b32 v80, v9, v10, s[60:61]
  s_waitcnt vmcnt(36)
  v_mfma_f32_16x16x32_bf16 v[32:35], v[96:99], v[16:19], 0
  v_mfma_f32_16x16x32_bf16 v[32:35], v[100:103], v[20:23], v[32:35]
  v_mfma_f32_16x16x32_bf16 v[32:35], v[104:107], v[24:27], v[32:35]
  v_mfma_f32_16x16x32_bf16 v[32:35], v[108:111], v[28:31], v[32:35]
  s_mov_b32 s56, 98304
  buffer_load_dwordx4 v[96:99], v3, s[12:15], s56 offen offset:0 nt
  buffer_load_dwordx4 v[100:103], v3, s[12:15], s56 offen offset:1024 nt
  buffer_load_dwordx4 v[104:107], v3, s[12:15], s56 offen offset:2048 nt
  buffer_load_dwordx4 v[108:111], v3, s[12:15], s56 offen offset:3072 nt
  v_add_f32_dpp v9, v37, v36 quad_perm:[1,0,3,2] row_mask:0xf bank_mask:0xf
  v_add_f32_dpp v10, v38, v39 quad_perm:[1,0,3,2] row_mask:0xf bank_mask:0xf
  v_cndmask_b32 v81, v9, v10, s[60:61]
  v_cvt_pk_bf16_f32 v11, v80, v81
  v_lshlrev_b32 v80, 16, v11
  v_and_b32 v81, 0xffff0000, v11
  v_mul_f32 v80, s57, v80
  v_mul_f32 v81, s57, v81
  v_cvt_pk_bf16_f32 v11, v80, v81
  v_lshlrev_b32 v80, 16, v11
  v_and_b32 v81, 0xffff0000, v11
  v_max3_f32 v6, v6, v80, v81
  s_waitcnt vmcnt(36)
  v_mfma_f32_16x16x32_bf16 v[36:39], v[112:115], v[16:19], 0
  v_mfma_f32_16x16x32_bf16 v[36:39], v[116:119], v[20:23], v[36:39]
  v_mfma_f32_16x16x32_bf16 v[36:39], v[120:123], v[24:27], v[36:39]
  v_mfma_f32_16x16x32_bf16 v[36:39], v[124:127], v[28:31], v[36:39]
  v_add_f32_dpp v9, v33, v32 quad_perm:[1,0,3,2] row_mask:0xf bank_mask:0xf
  v_add_f32_dpp v10, v34, v35 quad_perm:[1,0,3,2] row_mask:0xf bank_mask:0xf
  v_cndmask_b32 v82, v9, v10, s[60:61]
  s_waitcnt vmcnt(32)
  v_mfma_f32_16x16x32_bf16 v[32:35], v[128:131], v[16:19], 0
  v_mfma_f32_16x16x32_bf16 v[32:35], v[132:135], v[20:23], v[32:35]
  v_mfma_f32_16x16x32_bf16 v[32:35], v[136:139], v[24:27], v[32:35]
  v_mfma_f32_16x16x32_bf16 v[32:35], v[140:143], v[28:31], v[32:35]
  v_add_f32_dpp v9, v37, v36 quad_perm:[1,0,3,2] row_mask:0xf bank_mask:0xf
  v_add_f32_dpp v10, v38, v39 quad_perm:[1,0,3,2] row_mask:0xf bank_mask:0xf
  v_cndmask_b32 v83, v9, v10, s[60:61]
  v_cvt_pk_bf16_f32 v11, v82, v83
  v_lshlrev_b32 v82, 16, v11
  v_and_b32 v83, 0xffff0000, v11
  v_mul_f32 v82, s57, v82
  v_mul_f32 v83, s57, v83
  v_cvt_pk_bf16_f32 v11, v82, v83
  v_lshlrev_b32 v82, 16, v11
  v_and_b32 v83, 0xffff0000, v11
  v_max3_f32 v6, v6, v82, v83
  s_waitcnt vmcnt(28)
  v_mfma_f32_16x16x32_bf16 v[36:39], v[144:147], v[16:19], 0
  v_mfma_f32_16x16x32_bf16 v[36:39], v[148:151], v[20:23], v[36:39]
  v_mfma_f32_16x16x32_bf16 v[36:39], v[152:155], v[24:27], v[36:39]
  v_mfma_f32_16x16x32_bf16 v[36:39], v[156:159], v[28:31], v[36:39]
  v_add_f32_dpp v9, v33, v32 quad_perm:[1,0,3,2] row_mask:0xf bank_mask:0xf
  v_add_f32_dpp v10, v34, v35 quad_perm:[1,0,3,2] row_mask:0xf bank_mask:0xf
  v_cndmask_b32 v84, v9, v10, s[60:61]
  s_nop 4
  v_add_f32_dpp v9, v37, v36 quad_perm:[1,0,3,2] row_mask:0xf bank_mask:0xf
  v_add_f32_dpp v10, v38, v39 quad_perm:[1,0,3,2] row_mask:0xf bank_mask:0xf
  v_cndmask_b32 v85, v9, v10, s[60:61]
  v_cvt_pk_bf16_f32 v11, v84, v85
  v_lshlrev_b32 v84, 16, v11
  v_and_b32 v85, 0xffff0000, v11
  v_mul_f32 v84, s57, v84
  v_mul_f32 v85, s57, v85
  v_cvt_pk_bf16_f32 v11, v84, v85
  v_lshlrev_b32 v84, 16, v11
  v_and_b32 v85, 0xffff0000, v11
  v_max3_f32 v6, v6, v84, v85
  s_mov_b32 s56, 114688
  buffer_load_dwordx4 v[112:115], v3, s[12:15], s56 offen offset:0 nt
  v_mov_b32 v40, 0
  v_mov_b32 v41, 0
  v_mov_b32 v42, 0
  v_mov_b32 v43, 0
  v_mov_b32 v44, 0
  v_mov_b32 v45, 0
  v_mov_b32 v46, 0
  v_mov_b32 v47, 0
  v_mov_b32 v48, 0
  v_mov_b32 v49, 0
  v_mov_b32 v50, 0
  v_mov_b32 v51, 0
  v_mov_b32 v52, 0
  v_mov_b32 v53, 0
  v_mov_b32 v54, 0
  v_mov_b32 v55, 0
  v_mov_b32 v56, 0
  v_mov_b32 v57, 0
  v_mov_b32 v58, 0
  v_mov_b32 v59, 0
  v_mov_b32 v60, 0
  v_mov_b32 v61, 0
  v_mov_b32 v62, 0
  v_mov_b32 v63, 0
  v_mov_b32 v64, 0
  v_mov_b32 v65, 0
  buffer_load_dwordx4 v[116:119], v3, s[12:15], s56 offen offset:1024 nt
  v_max_f32_dpp v6, v6, v6 quad_perm:[1,0,3,2] row_mask:0xf bank_mask:0xf
  s_nop 1
  v_max_f32_dpp v6, v6, v6 quad_perm:[2,3,0,1] row_mask:0xf bank_mask:0xf
  v_mov_b32 v9, v6
  s_nop 1
  v_permlane16_swap_b32 v6, v9
  v_max_f32 v6, v6, v9
  v_mov_b32 v9, v6
  s_nop 1
  v_permlane32_swap_b32 v6, v9
  v_max_f32 v6, v6, v9
  buffer_load_dwordx4 v[120:123], v3, s[12:15], s56 offen offset:2048 nt
  s_mov_b32 s59, 1069066811
  v_mul_f32 v15, s59, v6
  buffer_load_dwordx4 v[124:127], v3, s[12:15], s56 offen offset:3072 nt
  v_fma_f32 v66, v66, s59, -v15
  v_fma_f32 v67, v67, s59, -v15
  v_fma_f32 v68, v68, s59, -v15
  v_fma_f32 v69, v69, s59, -v15
  v_fma_f32 v70, v70, s59, -v15
  v_fma_f32 v71, v71, s59, -v15
  v_fma_f32 v72, v72, s59, -v15
  v_fma_f32 v73, v73, s59, -v15
  v_fma_f32 v74, v74, s59, -v15
  v_fma_f32 v75, v75, s59, -v15
  s_mov_b32 s56, 131072
  buffer_load_dwordx4 v[128:131], v3, s[12:15], s56 offen offset:0 nt
  v_fma_f32 v76, v76, s59, -v15
  v_fma_f32 v77, v77, s59, -v15
  v_fma_f32 v78, v78, s59, -v15
  v_fma_f32 v79, v79, s59, -v15
  v_fma_f32 v80, v80, s59, -v15
  v_fma_f32 v81, v81, s59, -v15
  v_fma_f32 v82, v82, s59, -v15
  v_fma_f32 v83, v83, s59, -v15
  v_fma_f32 v84, v84, s59, -v15
  v_fma_f32 v85, v85, s59, -v15
  buffer_load_dwordx4 v[132:135], v3, s[12:15], s56 offen offset:1024 nt
  v_exp_f32 v66, v66
  v_exp_f32 v67, v67
  v_exp_f32 v68, v68
  v_exp_f32 v69, v69
  v_exp_f32 v70, v70
  v_exp_f32 v71, v71
  buffer_load_dwordx4 v[136:139], v3, s[12:15], s56 offen offset:2048 nt
  v_exp_f32 v72, v72
  v_exp_f32 v73, v73
  v_exp_f32 v74, v74
  v_exp_f32 v75, v75
  v_exp_f32 v76, v76
  v_exp_f32 v77, v77
  buffer_load_dwordx4 v[140:143], v3, s[12:15], s56 offen offset:3072 nt
  v_exp_f32 v78, v78
  v_exp_f32 v79, v79
  v_exp_f32 v80, v80
  v_exp_f32 v81, v81
  v_exp_f32 v82, v82
  v_exp_f32 v83, v83
  s_mov_b32 s56, 147456
  buffer_load_dwordx4 v[144:147], v3, s[12:15], s56 offen offset:0 nt
  v_exp_f32 v84, v84
  v_exp_f32 v85, v85
  v_add_f32 v7, v7, v66
  v_cvt_pk_bf16_f32 v66, v66, v66
  v_add_f32 v7, v7, v67
  v_cvt_pk_bf16_f32 v67, v67, v67
  v_add_f32 v7, v7, v68
  v_cvt_pk_bf16_f32 v68, v68, v68
  v_add_f32 v7, v7, v69
  v_cvt_pk_bf16_f32 v69, v69, v69
  v_add_f32 v7, v7, v70
  v_cvt_pk_bf16_f32 v70, v70, v70
  v_add_f32 v7, v7, v71
  v_cvt_pk_bf16_f32 v71, v71, v71
  buffer_load_dwordx4 v[148:151], v3, s[12:15], s56 offen offset:1024 nt
  v_add_f32 v7, v7, v72
  v_cvt_pk_bf16_f32 v72, v72, v72
  v_add_f32 v7, v7, v73
  v_cvt_pk_bf16_f32 v73, v73, v73
  v_add_f32 v7, v7, v74
  v_cvt_pk_bf16_f32 v74, v74, v74
  v_add_f32 v7, v7, v75
  v_cvt_pk_bf16_f32 v75, v75, v75
  v_add_f32 v7, v7, v76
  v_cvt_pk_bf16_f32 v76, v76, v76
  v_add_f32 v7, v7, v77
  v_cvt_pk_bf16_f32 v77, v77, v77
  buffer_load_dwordx4 v[152:155], v3, s[12:15], s56 offen offset:2048 nt
  v_add_f32 v7, v7, v78
  v_cvt_pk_bf16_f32 v78, v78, v78
  v_add_f32 v7, v7, v79
  v_cvt_pk_bf16_f32 v79, v79, v79
  v_add_f32 v7, v7, v80
  v_cvt_pk_bf16_f32 v80, v80, v80
  v_add_f32 v7, v7, v81
  v_cvt_pk_bf16_f32 v81, v81, v81
  v_add_f32 v7, v7, v82
  v_cvt_pk_bf16_f32 v82, v82, v82
  v_add_f32 v7, v7, v83
  v_cvt_pk_bf16_f32 v83, v83, v83
  buffer_load_dwordx4 v[156:159], v3, s[12:15], s56 offen offset:3072 nt
  v_add_f32 v7, v7, v84
  v_cvt_pk_bf16_f32 v84, v84, v84
  v_add_f32 v7, v7, v85
  v_cvt_pk_bf16_f32 v85, v85, v85
  v_mov_b32 v13, 1
  s_cmp_lt_u32 s3, 4
  s_cbranch_scc1 Lnocnt_7
  v_add_f32_dpp v7, v7, v7 quad_perm:[1,0,3,2] row_mask:0xf bank_mask:0xf
  s_nop 1
  v_add_f32_dpp v7, v7, v7 quad_perm:[2,3,0,1] row_mask:0xf bank_mask:0xf
  v_mov_b32 v9, v7
  s_nop 1
  v_permlane16_swap_b32 v7, v9
  v_add_f32 v7, v7, v9
  v_mov_b32 v9, v7
  s_nop 1
  v_permlane32_swap_b32 v7, v9
  v_add_f32 v7, v7, v9
  v_bfe_u32 v9, v1, 2, 2
  v_lshlrev_b32 v9, 5, v9
  s_lshl_b32 s9, s3, 2
  v_add_u32 v9, s9, v9
  ds_write_b32 v9, v6 offset:1280
  ds_write_b32 v9, v7 offset:1408
  s_waitcnt lgkmcnt(0)
  s_mov_b64 exec, 1
  ds_add_u32 v12, v13 offset:4
  s_mov_b64 exec, -1
Lnocnt_7:
  s_lshl_b32 s9, s3, 11
  v_lshlrev_b32 v11, 5, v1
  v_add_u32 v11, s9, v11
  v_lshlrev_b32 v10, 3, v0
  s_mul_i32 s7, s5, 49152
  s_lshl_b32 s9, s6, 10
  s_add_u32 s7, s7, s9
  s_mul_i32 s9, s3, 12288
  s_add_u32 s7, s7, s9
  s_add_u32 s7, s7, 1048576
  v_and_b32_dpp v50, v66, v4 quad_perm:[0,0,0,0] row_mask:0xf bank_mask:0xf
  v_and_b32_dpp v51, v66, v5 quad_perm:[0,0,0,0] row_mask:0xf bank_mask:0xf
  v_and_b32_dpp v54, v66, v4 quad_perm:[1,1,1,1] row_mask:0xf bank_mask:0xf
  v_and_b32_dpp v55, v66, v5 quad_perm:[1,1,1,1] row_mask:0xf bank_mask:0xf
  v_and_b32_dpp v58, v66, v4 quad_perm:[2,2,2,2] row_mask:0xf bank_mask:0xf
  v_and_b32_dpp v59, v66, v5 quad_perm:[2,2,2,2] row_mask:0xf bank_mask:0xf
  s_waitcnt vmcnt(39)
  v_mfma_f32_16x16x32_bf16 v[40:43], v[50:53], v[160:163], v[40:43]
  v_mfma_f32_16x16x32_bf16 v[44:47], v[48:51], v[160:163], v[44:47]
  s_mov_b32 s56, 163840
  buffer_load_dwordx4 v[160:163], v3, s[12:15], s56 offen offset:0 nt
  v_and_b32_dpp v62, v66, v4 quad_perm:[3,3,3,3] row_mask:0xf bank_mask:0xf
  v_and_b32_dpp v63, v66, v5 quad_perm:[3,3,3,3] row_mask:0xf bank_mask:0xf
  s_waitcnt vmcnt(39)
  v_mfma_f32_16x16x32_bf16 v[40:43], v[54:57], v[164:167], v[40:43]
  v_mfma_f32_16x16x32_bf16 v[44:47], v[52:55], v[164:167], v[44:47]
  buffer_load_dwordx4 v[164:167], v3, s[12:15], s56 offen offset:1024 nt
  v_and_b32_dpp v50, v67, v4 quad_perm:[0,0,0,0] row_mask:0xf bank_mask:0xf
  v_and_b32_dpp v51, v67, v5 quad_perm:[0,0,0,0] row_mask:0xf bank_mask:0xf
  s_waitcnt vmcnt(39)
  v_mfma_f32_16x16x32_bf16 v[40:43], v[58:61], v[168:171], v[40:43]
  v_mfma_f32_16x16x32_bf16 v[44:47], v[56:59], v[168:171], v[44:47]
  buffer_load_dwordx4 v[168:171], v3, s[12:15], s56 offen offset:2048 nt
  v_and_b32_dpp v54, v67, v4 quad_perm:[1,1,1,1] row_mask:0xf bank_mask:0xf
  v_and_b32_dpp v55, v67, v5 quad_perm:[1,1,1,1] row_mask:0xf bank_mask:0xf
  s_waitcnt vmcnt(39)
  v_mfma_f32_16x16x32_bf16 v[40:43], v[62:65], v[172:175], v[40:43]
  v_mfma_f32_16x16x32_bf16 v[44:47], v[60:63], v[172:175], v[44:47]
  buffer_load_dwordx4 v[172:175], v3, s[12:15], s56 offen offset:3072 nt
  v_and_b32_dpp v58, v67, v4 quad_perm:[2,2,2,2] row_mask:0xf bank_mask:0xf
  v_and_b32_dpp v59, v67, v5 quad_perm:[2,2,2,2] row_mask:0xf bank_mask:0xf
  s_waitcnt vmcnt(39)
  v_mfma_f32_16x16x32_bf16 v[40:43], v[50:53], v[176:179], v[40:43]
  v_mfma_f32_16x16x32_bf16 v[44:47], v[48:51], v[176:179], v[44:47]
  s_mov_b32 s56, 180224
  buffer_load_dwordx4 v[176:179], v3, s[12:15], s56 offen offset:0 nt
  v_and_b32_dpp v62, v67, v4 quad_perm:[3,3,3,3] row_mask:0xf bank_mask:0xf
  v_and_b32_dpp v63, v67, v5 quad_perm:[3,3,3,3] row_mask:0xf bank_mask:0xf
  s_waitcnt vmcnt(39)
  v_mfma_f32_16x16x32_bf16 v[40:43], v[54:57], v[180:183], v[40:43]
  v_mfma_f32_16x16x32_bf16 v[44:47], v[52:55], v[180:183], v[44:47]
  buffer_load_dwordx4 v[180:183], v3, s[12:15], s56 offen offset:1024 nt
  v_and_b32_dpp v50, v68, v4 quad_perm:[0,0,0,0] row_mask:0xf bank_mask:0xf
  v_and_b32_dpp v51, v68, v5 quad_perm:[0,0,0,0] row_mask:0xf bank_mask:0xf
  s_waitcnt vmcnt(39)
  v_mfma_f32_16x16x32_bf16 v[40:43], v[58:61], v[184:187], v[40:43]
  v_mfma_f32_16x16x32_bf16 v[44:47], v[56:59], v[184:187], v[44:47]
  buffer_load_dwordx4 v[184:187], v3, s[12:15], s56 offen offset:2048 nt
  v_and_b32_dpp v54, v68, v4 quad_perm:[1,1,1,1] row_mask:0xf bank_mask:0xf
  v_and_b32_dpp v55, v68, v5 quad_perm:[1,1,1,1] row_mask:0xf bank_mask:0xf
  s_waitcnt vmcnt(39)
  v_mfma_f32_16x16x32_bf16 v[40:43], v[62:65], v[188:191], v[40:43]
  v_mfma_f32_16x16x32_bf16 v[44:47], v[60:63], v[188:191], v[44:47]
  buffer_load_dwordx4 v[188:191], v3, s[12:15], s56 offen offset:3072 nt
  v_and_b32_dpp v58, v68, v4 quad_perm:[2,2,2,2] row_mask:0xf bank_mask:0xf
  v_and_b32_dpp v59, v68, v5 quad_perm:[2,2,2,2] row_mask:0xf bank_mask:0xf
  s_waitcnt vmcnt(39)
  v_mfma_f32_16x16x32_bf16 v[40:43], v[50:53], v[192:195], v[40:43]
  v_mfma_f32_16x16x32_bf16 v[44:47], v[48:51], v[192:195], v[44:47]
  s_mov_b32 s56, 196608
  buffer_load_dwordx4 v[192:195], v3, s[12:15], s56 offen offset:0 nt
  v_and_b32_dpp v62, v68, v4 quad_perm:[3,3,3,3] row_mask:0xf bank_mask:0xf
  v_and_b32_dpp v63, v68, v5 quad_perm:[3,3,3,3] row_mask:0xf bank_mask:0xf
  s_waitcnt vmcnt(39)
  v_mfma_f32_16x16x32_bf16 v[40:43], v[54:57], v[196:199], v[40:43]
  v_mfma_f32_16x16x32_bf16 v[44:47], v[52:55], v[196:199], v[44:47]
  buffer_load_dwordx4 v[196:199], v3, s[12:15], s56 offen offset:1024 nt
  v_and_b32_dpp v50, v69, v4 quad_perm:[0,0,0,0] row_mask:0xf bank_mask:0xf
  v_and_b32_dpp v51, v69, v5 quad_perm:[0,0,0,0] row_mask:0xf bank_mask:0xf
  s_waitcnt vmcnt(39)
  v_mfma_f32_16x16x32_bf16 v[40:43], v[58:61], v[200:203], v[40:43]
  v_mfma_f32_16x16x32_bf16 v[44:47], v[56:59], v[200:203], v[44:47]
  buffer_load_dwordx4 v[200:203], v3, s[12:15], s56 offen offset:2048 nt
  v_and_b32_dpp v54, v69, v4 quad_perm:[1,1,1,1] row_mask:0xf bank_mask:0xf
  v_and_b32_dpp v55, v69, v5 quad_perm:[1,1,1,1] row_mask:0xf bank_mask:0xf
  s_waitcnt vmcnt(39)
  v_mfma_f32_16x16x32_bf16 v[40:43], v[62:65], v[204:207], v[40:43]
  v_mfma_f32_16x16x32_bf16 v[44:47], v[60:63], v[204:207], v[44:47]
  buffer_load_dwordx4 v[204:207], v3, s[12:15], s56 offen offset:3072 nt
  v_and_b32_dpp v58, v69, v4 quad_perm:[2,2,2,2] row_mask:0xf bank_mask:0xf
  v_and_b32_dpp v59, v69, v5 quad_perm:[2,2,2,2] row_mask:0xf bank_mask:0xf
  s_waitcnt vmcnt(39)
  v_mfma_f32_16x16x32_bf16 v[40:43], v[50:53], v[208:211], v[40:43]
  v_mfma_f32_16x16x32_bf16 v[44:47], v[48:51], v[208:211], v[44:47]
  s_mov_b32 s56, 212992
  buffer_load_dwordx4 v[208:211], v3, s[12:15], s56 offen offset:0 nt
  v_and_b32_dpp v62, v69, v4 quad_perm:[3,3,3,3] row_mask:0xf bank_mask:0xf
  v_and_b32_dpp v63, v69, v5 quad_perm:[3,3,3,3] row_mask:0xf bank_mask:0xf
  s_waitcnt vmcnt(39)
  v_mfma_f32_16x16x32_bf16 v[40:43], v[54:57], v[212:215], v[40:43]
  v_mfma_f32_16x16x32_bf16 v[44:47], v[52:55], v[212:215], v[44:47]
  buffer_load_dwordx4 v[212:215], v3, s[12:15], s56 offen offset:1024 nt
  v_and_b32_dpp v50, v70, v4 quad_perm:[0,0,0,0] row_mask:0xf bank_mask:0xf
  v_and_b32_dpp v51, v70, v5 quad_perm:[0,0,0,0] row_mask:0xf bank_mask:0xf
  s_waitcnt vmcnt(39)
  v_mfma_f32_16x16x32_bf16 v[40:43], v[58:61], v[216:219], v[40:43]
  v_mfma_f32_16x16x32_bf16 v[44:47], v[56:59], v[216:219], v[44:47]
  buffer_load_dwordx4 v[216:219], v3, s[12:15], s56 offen offset:2048 nt
  v_and_b32_dpp v54, v70, v4 quad_perm:[1,1,1,1] row_mask:0xf bank_mask:0xf
  v_and_b32_dpp v55, v70, v5 quad_perm:[1,1,1,1] row_mask:0xf bank_mask:0xf
  s_waitcnt vmcnt(39)
  v_mfma_f32_16x16x32_bf16 v[40:43], v[62:65], v[220:223], v[40:43]
  v_mfma_f32_16x16x32_bf16 v[44:47], v[60:63], v[220:223], v[44:47]
  buffer_load_dwordx4 v[220:223], v3, s[12:15], s56 offen offset:3072 nt
  v_and_b32_dpp v58, v70, v4 quad_perm:[2,2,2,2] row_mask:0xf bank_mask:0xf
  v_and_b32_dpp v59, v70, v5 quad_perm:[2,2,2,2] row_mask:0xf bank_mask:0xf
  s_waitcnt vmcnt(39)
  v_mfma_f32_16x16x32_bf16 v[40:43], v[50:53], v[224:227], v[40:43]
  v_mfma_f32_16x16x32_bf16 v[44:47], v[48:51], v[224:227], v[44:47]
  s_mov_b32 s56, 229376
  buffer_load_dwordx4 v[224:227], v3, s[12:15], s56 offen offset:0 nt
  v_and_b32_dpp v62, v70, v4 quad_perm:[3,3,3,3] row_mask:0xf bank_mask:0xf
  v_and_b32_dpp v63, v70, v5 quad_perm:[3,3,3,3] row_mask:0xf bank_mask:0xf
  s_waitcnt vmcnt(39)
  v_mfma_f32_16x16x32_bf16 v[40:43], v[54:57], v[228:231], v[40:43]
  v_mfma_f32_16x16x32_bf16 v[44:47], v[52:55], v[228:231], v[44:47]
  buffer_load_dwordx4 v[228:231], v3, s[12:15], s56 offen offset:1024 nt
  v_and_b32_dpp v50, v71, v4 quad_perm:[0,0,0,0] row_mask:0xf bank_mask:0xf
  v_and_b32_dpp v51, v71, v5 quad_perm:[0,0,0,0] row_mask:0xf bank_mask:0xf
  s_waitcnt vmcnt(39)
  v_mfma_f32_16x16x32_bf16 v[40:43], v[58:61], v[232:235], v[40:43]
  v_mfma_f32_16x16x32_bf16 v[44:47], v[56:59], v[232:235], v[44:47]
  buffer_load_dwordx4 v[232:235], v3, s[12:15], s56 offen offset:2048 nt
  v_and_b32_dpp v54, v71, v4 quad_perm:[1,1,1,1] row_mask:0xf bank_mask:0xf
  v_and_b32_dpp v55, v71, v5 quad_perm:[1,1,1,1] row_mask:0xf bank_mask:0xf
  s_waitcnt vmcnt(39)
  v_mfma_f32_16x16x32_bf16 v[40:43], v[62:65], v[236:239], v[40:43]
  v_mfma_f32_16x16x32_bf16 v[44:47], v[60:63], v[236:239], v[44:47]
  buffer_load_dwordx4 v[236:239], v3, s[12:15], s56 offen offset:3072 nt
  v_and_b32_dpp v58, v71, v4 quad_perm:[2,2,2,2] row_mask:0xf bank_mask:0xf
  v_and_b32_dpp v59, v71, v5 quad_perm:[2,2,2,2] row_mask:0xf bank_mask:0xf
  s_waitcnt vmcnt(39)
  v_mfma_f32_16x16x32_bf16 v[40:43], v[50:53], v[240:243], v[40:43]
  v_mfma_f32_16x16x32_bf16 v[44:47], v[48:51], v[240:243], v[44:47]
  s_mov_b32 s56, 245760
  buffer_load_dwordx4 v[240:243], v3, s[12:15], s56 offen offset:0 nt
  v_and_b32_dpp v62, v71, v4 quad_perm:[3,3,3,3] row_mask:0xf bank_mask:0xf
  v_and_b32_dpp v63, v71, v5 quad_perm:[3,3,3,3] row_mask:0xf bank_mask:0xf
  s_waitcnt vmcnt(39)
  v_mfma_f32_16x16x32_bf16 v[40:43], v[54:57], v[244:247], v[40:43]
  v_mfma_f32_16x16x32_bf16 v[44:47], v[52:55], v[244:247], v[44:47]
  buffer_load_dwordx4 v[244:247], v3, s[12:15], s56 offen offset:1024 nt
  v_and_b32_dpp v50, v72, v4 quad_perm:[0,0,0,0] row_mask:0xf bank_mask:0xf
  v_and_b32_dpp v51, v72, v5 quad_perm:[0,0,0,0] row_mask:0xf bank_mask:0xf
  s_waitcnt vmcnt(39)
  v_mfma_f32_16x16x32_bf16 v[40:43], v[58:61], v[248:251], v[40:43]
  v_mfma_f32_16x16x32_bf16 v[44:47], v[56:59], v[248:251], v[44:47]
  buffer_load_dwordx4 v[248:251], v3, s[12:15], s56 offen offset:2048 nt
  v_and_b32_dpp v54, v72, v4 quad_perm:[1,1,1,1] row_mask:0xf bank_mask:0xf
  v_and_b32_dpp v55, v72, v5 quad_perm:[1,1,1,1] row_mask:0xf bank_mask:0xf
  s_waitcnt vmcnt(39)
  v_mfma_f32_16x16x32_bf16 v[40:43], v[62:65], v[252:255], v[40:43]
  v_mfma_f32_16x16x32_bf16 v[44:47], v[60:63], v[252:255], v[44:47]
  buffer_load_dwordx4 v[252:255], v3, s[12:15], s56 offen offset:3072 nt
  v_and_b32_dpp v58, v72, v4 quad_perm:[2,2,2,2] row_mask:0xf bank_mask:0xf
  v_and_b32_dpp v59, v72, v5 quad_perm:[2,2,2,2] row_mask:0xf bank_mask:0xf
  s_waitcnt vmcnt(39)
  v_mfma_f32_16x16x32_bf16 v[40:43], v[50:53], v[96:99], v[40:43]
  v_mfma_f32_16x16x32_bf16 v[44:47], v[48:51], v[96:99], v[44:47]
  s_mov_b32 s56, 262144
  buffer_load_dwordx4 v[96:99], v3, s[12:15], s56 offen offset:0 nt
  v_and_b32_dpp v62, v72, v4 quad_perm:[3,3,3,3] row_mask:0xf bank_mask:0xf
  v_and_b32_dpp v63, v72, v5 quad_perm:[3,3,3,3] row_mask:0xf bank_mask:0xf
  s_waitcnt vmcnt(39)
  v_mfma_f32_16x16x32_bf16 v[40:43], v[54:57], v[100:103], v[40:43]
  v_mfma_f32_16x16x32_bf16 v[44:47], v[52:55], v[100:103], v[44:47]
  buffer_load_dwordx4 v[100:103], v3, s[12:15], s56 offen offset:1024 nt
  v_and_b32_dpp v50, v73, v4 quad_perm:[0,0,0,0] row_mask:0xf bank_mask:0xf
  v_and_b32_dpp v51, v73, v5 quad_perm:[0,0,0,0] row_mask:0xf bank_mask:0xf
  s_waitcnt vmcnt(39)
  v_mfma_f32_16x16x32_bf16 v[40:43], v[58:61], v[104:107], v[40:43]
  v_mfma_f32_16x16x32_bf16 v[44:47], v[56:59], v[104:107], v[44:47]
  buffer_load_dwordx4 v[104:107], v3, s[12:15], s56 offen offset:2048 nt
  v_and_b32_dpp v54, v73, v4 quad_perm:[1,1,1,1] row_mask:0xf bank_mask:0xf
  v_and_b32_dpp v55, v73, v5 quad_perm:[1,1,1,1] row_mask:0xf bank_mask:0xf
  s_waitcnt vmcnt(39)
  v_mfma_f32_16x16x32_bf16 v[40:43], v[62:65], v[108:111], v[40:43]
  v_mfma_f32_16x16x32_bf16 v[44:47], v[60:63], v[108:111], v[44:47]
  buffer_load_dwordx4 v[108:111], v3, s[12:15], s56 offen offset:3072 nt
  v_and_b32_dpp v58, v73, v4 quad_perm:[2,2,2,2] row_mask:0xf bank_mask:0xf
  v_and_b32_dpp v59, v73, v5 quad_perm:[2,2,2,2] row_mask:0xf bank_mask:0xf
  s_waitcnt vmcnt(39)
  v_mfma_f32_16x16x32_bf16 v[40:43], v[50:53], v[112:115], v[40:43]
  v_mfma_f32_16x16x32_bf16 v[44:47], v[48:51], v[112:115], v[44:47]
  s_mov_b32 s56, 278528
  buffer_load_dwordx4 v[112:115], v3, s[12:15], s56 offen offset:0 nt
  v_and_b32_dpp v62, v73, v4 quad_perm:[3,3,3,3] row_mask:0xf bank_mask:0xf
  v_and_b32_dpp v63, v73, v5 quad_perm:[3,3,3,3] row_mask:0xf bank_mask:0xf
  s_waitcnt vmcnt(39)
  v_mfma_f32_16x16x32_bf16 v[40:43], v[54:57], v[116:119], v[40:43]
  v_mfma_f32_16x16x32_bf16 v[44:47], v[52:55], v[116:119], v[44:47]
  buffer_load_dwordx4 v[116:119], v3, s[12:15], s56 offen offset:1024 nt
  v_and_b32_dpp v50, v74, v4 quad_perm:[0,0,0,0] row_mask:0xf bank_mask:0xf
  v_and_b32_dpp v51, v74, v5 quad_perm:[0,0,0,0] row_mask:0xf bank_mask:0xf
  s_waitcnt vmcnt(39)
  v_mfma_f32_16x16x32_bf16 v[40:43], v[58:61], v[120:123], v[40:43]
  v_mfma_f32_16x16x32_bf16 v[44:47], v[56:59], v[120:123], v[44:47]
  buffer_load_dwordx4 v[120:123], v3, s[12:15], s56 offen offset:2048 nt
  v_and_b32_dpp v54, v74, v4 quad_perm:[1,1,1,1] row_mask:0xf bank_mask:0xf
  v_and_b32_dpp v55, v74, v5 quad_perm:[1,1,1,1] row_mask:0xf bank_mask:0xf
  s_waitcnt vmcnt(39)
  v_mfma_f32_16x16x32_bf16 v[40:43], v[62:65], v[124:127], v[40:43]
  v_mfma_f32_16x16x32_bf16 v[44:47], v[60:63], v[124:127], v[44:47]
  buffer_load_dwordx4 v[124:127], v3, s[12:15], s56 offen offset:3072 nt
  v_and_b32_dpp v58, v74, v4 quad_perm:[2,2,2,2] row_mask:0xf bank_mask:0xf
  v_and_b32_dpp v59, v74, v5 quad_perm:[2,2,2,2] row_mask:0xf bank_mask:0xf
  s_waitcnt vmcnt(39)
  v_mfma_f32_16x16x32_bf16 v[40:43], v[50:53], v[128:131], v[40:43]
  v_mfma_f32_16x16x32_bf16 v[44:47], v[48:51], v[128:131], v[44:47]
  s_mov_b32 s56, 294912
  buffer_load_dwordx4 v[128:131], v3, s[12:15], s56 offen offset:0 nt
  v_and_b32_dpp v62, v74, v4 quad_perm:[3,3,3,3] row_mask:0xf bank_mask:0xf
  v_and_b32_dpp v63, v74, v5 quad_perm:[3,3,3,3] row_mask:0xf bank_mask:0xf
  s_waitcnt vmcnt(39)
  v_mfma_f32_16x16x32_bf16 v[40:43], v[54:57], v[132:135], v[40:43]
  v_mfma_f32_16x16x32_bf16 v[44:47], v[52:55], v[132:135], v[44:47]
  buffer_load_dwordx4 v[132:135], v3, s[12:15], s56 offen offset:1024 nt
  v_and_b32_dpp v50, v75, v4 quad_perm:[0,0,0,0] row_mask:0xf bank_mask:0xf
  v_and_b32_dpp v51, v75, v5 quad_perm:[0,0,0,0] row_mask:0xf bank_mask:0xf
  s_waitcnt vmcnt(39)
  v_mfma_f32_16x16x32_bf16 v[40:43], v[58:61], v[136:139], v[40:43]
  v_mfma_f32_16x16x32_bf16 v[44:47], v[56:59], v[136:139], v[44:47]
  buffer_load_dwordx4 v[136:139], v3, s[12:15], s56 offen offset:2048 nt
  v_and_b32_dpp v54, v75, v4 quad_perm:[1,1,1,1] row_mask:0xf bank_mask:0xf
  v_and_b32_dpp v55, v75, v5 quad_perm:[1,1,1,1] row_mask:0xf bank_mask:0xf
  s_waitcnt vmcnt(39)
  v_mfma_f32_16x16x32_bf16 v[40:43], v[62:65], v[140:143], v[40:43]
  v_mfma_f32_16x16x32_bf16 v[44:47], v[60:63], v[140:143], v[44:47]
  buffer_load_dwordx4 v[140:143], v3, s[12:15], s56 offen offset:3072 nt
  v_and_b32_dpp v58, v75, v4 quad_perm:[2,2,2,2] row_mask:0xf bank_mask:0xf
  v_and_b32_dpp v59, v75, v5 quad_perm:[2,2,2,2] row_mask:0xf bank_mask:0xf
  s_waitcnt vmcnt(39)
  v_mfma_f32_16x16x32_bf16 v[40:43], v[50:53], v[144:147], v[40:43]
  v_mfma_f32_16x16x32_bf16 v[44:47], v[48:51], v[144:147], v[44:47]
  s_mov_b32 s56, 311296
  buffer_load_dwordx4 v[144:147], v3, s[12:15], s56 offen offset:0 nt
  v_and_b32_dpp v62, v75, v4 quad_perm:[3,3,3,3] row_mask:0xf bank_mask:0xf
  v_and_b32_dpp v63, v75, v5 quad_perm:[3,3,3,3] row_mask:0xf bank_mask:0xf
  s_waitcnt vmcnt(39)
  v_mfma_f32_16x16x32_bf16 v[40:43], v[54:57], v[148:151], v[40:43]
  v_mfma_f32_16x16x32_bf16 v[44:47], v[52:55], v[148:151], v[44:47]
  buffer_load_dwordx4 v[148:151], v3, s[12:15], s56 offen offset:1024 nt
  v_and_b32_dpp v50, v76, v4 quad_perm:[0,0,0,0] row_mask:0xf bank_mask:0xf
  v_and_b32_dpp v51, v76, v5 quad_perm:[0,0,0,0] row_mask:0xf bank_mask:0xf
  s_waitcnt vmcnt(39)
  v_mfma_f32_16x16x32_bf16 v[40:43], v[58:61], v[152:155], v[40:43]
  v_mfma_f32_16x16x32_bf16 v[44:47], v[56:59], v[152:155], v[44:47]
  buffer_load_dwordx4 v[152:155], v3, s[12:15], s56 offen offset:2048 nt
  v_and_b32_dpp v54, v76, v4 quad_perm:[1,1,1,1] row_mask:0xf bank_mask:0xf
  v_and_b32_dpp v55, v76, v5 quad_perm:[1,1,1,1] row_mask:0xf bank_mask:0xf
  s_waitcnt vmcnt(39)
  v_mfma_f32_16x16x32_bf16 v[40:43], v[62:65], v[156:159], v[40:43]
  v_mfma_f32_16x16x32_bf16 v[44:47], v[60:63], v[156:159], v[44:47]
  buffer_load_dwordx4 v[156:159], v3, s[12:15], s56 offen offset:3072 nt
  v_and_b32_dpp v58, v76, v4 quad_perm:[2,2,2,2] row_mask:0xf bank_mask:0xf
  v_and_b32_dpp v59, v76, v5 quad_perm:[2,2,2,2] row_mask:0xf bank_mask:0xf
  s_waitcnt vmcnt(39)
  v_mfma_f32_16x16x32_bf16 v[40:43], v[50:53], v[160:163], v[40:43]
  v_mfma_f32_16x16x32_bf16 v[44:47], v[48:51], v[160:163], v[44:47]
  v_and_b32_dpp v62, v76, v4 quad_perm:[3,3,3,3] row_mask:0xf bank_mask:0xf
  v_and_b32_dpp v63, v76, v5 quad_perm:[3,3,3,3] row_mask:0xf bank_mask:0xf
  s_waitcnt vmcnt(38)
  v_mfma_f32_16x16x32_bf16 v[40:43], v[54:57], v[164:167], v[40:43]
  v_mfma_f32_16x16x32_bf16 v[44:47], v[52:55], v[164:167], v[44:47]
  v_and_b32_dpp v50, v77, v4 quad_perm:[0,0,0,0] row_mask:0xf bank_mask:0xf
  v_and_b32_dpp v51, v77, v5 quad_perm:[0,0,0,0] row_mask:0xf bank_mask:0xf
  s_waitcnt vmcnt(37)
  v_mfma_f32_16x16x32_bf16 v[40:43], v[58:61], v[168:171], v[40:43]
  v_mfma_f32_16x16x32_bf16 v[44:47], v[56:59], v[168:171], v[44:47]
  v_and_b32_dpp v54, v77, v4 quad_perm:[1,1,1,1] row_mask:0xf bank_mask:0xf
  v_and_b32_dpp v55, v77, v5 quad_perm:[1,1,1,1] row_mask:0xf bank_mask:0xf
  s_waitcnt vmcnt(36)
  v_mfma_f32_16x16x32_bf16 v[40:43], v[62:65], v[172:175], v[40:43]
  v_mfma_f32_16x16x32_bf16 v[44:47], v[60:63], v[172:175], v[44:47]
  v_and_b32_dpp v58, v77, v4 quad_perm:[2,2,2,2] row_mask:0xf bank_mask:0xf
  v_and_b32_dpp v59, v77, v5 quad_perm:[2,2,2,2] row_mask:0xf bank_mask:0xf
  s_waitcnt vmcnt(35)
  v_mfma_f32_16x16x32_bf16 v[40:43], v[50:53], v[176:179], v[40:43]
  v_mfma_f32_16x16x32_bf16 v[44:47], v[48:51], v[176:179], v[44:47]
  v_and_b32_dpp v62, v77, v4 quad_perm:[3,3,3,3] row_mask:0xf bank_mask:0xf
  v_and_b32_dpp v63, v77, v5 quad_perm:[3,3,3,3] row_mask:0xf bank_mask:0xf
  s_waitcnt vmcnt(34)
  v_mfma_f32_16x16x32_bf16 v[40:43], v[54:57], v[180:183], v[40:43]
  v_mfma_f32_16x16x32_bf16 v[44:47], v[52:55], v[180:183], v[44:47]
  v_and_b32_dpp v50, v78, v4 quad_perm:[0,0,0,0] row_mask:0xf bank_mask:0xf
  v_and_b32_dpp v51, v78, v5 quad_perm:[0,0,0,0] row_mask:0xf bank_mask:0xf
  s_waitcnt vmcnt(33)
  v_mfma_f32_16x16x32_bf16 v[40:43], v[58:61], v[184:187], v[40:43]
  v_mfma_f32_16x16x32_bf16 v[44:47], v[56:59], v[184:187], v[44:47]
  v_and_b32_dpp v54, v78, v4 quad_perm:[1,1,1,1] row_mask:0xf bank_mask:0xf
  v_and_b32_dpp v55, v78, v5 quad_perm:[1,1,1,1] row_mask:0xf bank_mask:0xf
  s_waitcnt vmcnt(32)
  v_mfma_f32_16x16x32_bf16 v[40:43], v[62:65], v[188:191], v[40:43]
  v_mfma_f32_16x16x32_bf16 v[44:47], v[60:63], v[188:191], v[44:47]
  v_and_b32_dpp v58, v78, v4 quad_perm:[2,2,2,2] row_mask:0xf bank_mask:0xf
  v_and_b32_dpp v59, v78, v5 quad_perm:[2,2,2,2] row_mask:0xf bank_mask:0xf
  s_waitcnt vmcnt(31)
  v_mfma_f32_16x16x32_bf16 v[40:43], v[50:53], v[192:195], v[40:43]
  v_mfma_f32_16x16x32_bf16 v[44:47], v[48:51], v[192:195], v[44:47]
  v_and_b32_dpp v62, v78, v4 quad_perm:[3,3,3,3] row_mask:0xf bank_mask:0xf
  v_and_b32_dpp v63, v78, v5 quad_perm:[3,3,3,3] row_mask:0xf bank_mask:0xf
  s_waitcnt vmcnt(30)
  v_mfma_f32_16x16x32_bf16 v[40:43], v[54:57], v[196:199], v[40:43]
  v_mfma_f32_16x16x32_bf16 v[44:47], v[52:55], v[196:199], v[44:47]
  v_and_b32_dpp v50, v79, v4 quad_perm:[0,0,0,0] row_mask:0xf bank_mask:0xf
  v_and_b32_dpp v51, v79, v5 quad_perm:[0,0,0,0] row_mask:0xf bank_mask:0xf
  s_waitcnt vmcnt(29)
  v_mfma_f32_16x16x32_bf16 v[40:43], v[58:61], v[200:203], v[40:43]
  v_mfma_f32_16x16x32_bf16 v[44:47], v[56:59], v[200:203], v[44:47]
  v_and_b32_dpp v54, v79, v4 quad_perm:[1,1,1,1] row_mask:0xf bank_mask:0xf
  v_and_b32_dpp v55, v79, v5 quad_perm:[1,1,1,1] row_mask:0xf bank_mask:0xf
  s_waitcnt vmcnt(28)
  v_mfma_f32_16x16x32_bf16 v[40:43], v[62:65], v[204:207], v[40:43]
  v_mfma_f32_16x16x32_bf16 v[44:47], v[60:63], v[204:207], v[44:47]
  v_and_b32_dpp v58, v79, v4 quad_perm:[2,2,2,2] row_mask:0xf bank_mask:0xf
  v_and_b32_dpp v59, v79, v5 quad_perm:[2,2,2,2] row_mask:0xf bank_mask:0xf
  s_waitcnt vmcnt(27)
  v_mfma_f32_16x16x32_bf16 v[40:43], v[50:53], v[208:211], v[40:43]
  v_mfma_f32_16x16x32_bf16 v[44:47], v[48:51], v[208:211], v[44:47]
  v_and_b32_dpp v62, v79, v4 quad_perm:[3,3,3,3] row_mask:0xf bank_mask:0xf
  v_and_b32_dpp v63, v79, v5 quad_perm:[3,3,3,3] row_mask:0xf bank_mask:0xf
  s_waitcnt vmcnt(26)
  v_mfma_f32_16x16x32_bf16 v[40:43], v[54:57], v[212:215], v[40:43]
  v_mfma_f32_16x16x32_bf16 v[44:47], v[52:55], v[212:215], v[44:47]
  v_and_b32_dpp v50, v80, v4 quad_perm:[0,0,0,0] row_mask:0xf bank_mask:0xf
  v_and_b32_dpp v51, v80, v5 quad_perm:[0,0,0,0] row_mask:0xf bank_mask:0xf
  s_waitcnt vmcnt(25)
  v_mfma_f32_16x16x32_bf16 v[40:43], v[58:61], v[216:219], v[40:43]
  v_mfma_f32_16x16x32_bf16 v[44:47], v[56:59], v[216:219], v[44:47]
  v_and_b32_dpp v54, v80, v4 quad_perm:[1,1,1,1] row_mask:0xf bank_mask:0xf
  v_and_b32_dpp v55, v80, v5 quad_perm:[1,1,1,1] row_mask:0xf bank_mask:0xf
  s_waitcnt vmcnt(24)
  v_mfma_f32_16x16x32_bf16 v[40:43], v[62:65], v[220:223], v[40:43]
  v_mfma_f32_16x16x32_bf16 v[44:47], v[60:63], v[220:223], v[44:47]
  v_and_b32_dpp v58, v80, v4 quad_perm:[2,2,2,2] row_mask:0xf bank_mask:0xf
  v_and_b32_dpp v59, v80, v5 quad_perm:[2,2,2,2] row_mask:0xf bank_mask:0xf
  s_waitcnt vmcnt(23)
  v_mfma_f32_16x16x32_bf16 v[40:43], v[50:53], v[224:227], v[40:43]
  v_mfma_f32_16x16x32_bf16 v[44:47], v[48:51], v[224:227], v[44:47]
  v_and_b32_dpp v62, v80, v4 quad_perm:[3,3,3,3] row_mask:0xf bank_mask:0xf
  v_and_b32_dpp v63, v80, v5 quad_perm:[3,3,3,3] row_mask:0xf bank_mask:0xf
  s_waitcnt vmcnt(22)
  v_mfma_f32_16x16x32_bf16 v[40:43], v[54:57], v[228:231], v[40:43]
  v_mfma_f32_16x16x32_bf16 v[44:47], v[52:55], v[228:231], v[44:47]
  v_and_b32_dpp v50, v81, v4 quad_perm:[0,0,0,0] row_mask:0xf bank_mask:0xf
  v_and_b32_dpp v51, v81, v5 quad_perm:[0,0,0,0] row_mask:0xf bank_mask:0xf
  s_waitcnt vmcnt(21)
  v_mfma_f32_16x16x32_bf16 v[40:43], v[58:61], v[232:235], v[40:43]
  v_mfma_f32_16x16x32_bf16 v[44:47], v[56:59], v[232:235], v[44:47]
  v_and_b32_dpp v54, v81, v4 quad_perm:[1,1,1,1] row_mask:0xf bank_mask:0xf
  v_and_b32_dpp v55, v81, v5 quad_perm:[1,1,1,1] row_mask:0xf bank_mask:0xf
  s_waitcnt vmcnt(20)
  v_mfma_f32_16x16x32_bf16 v[40:43], v[62:65], v[236:239], v[40:43]
  v_mfma_f32_16x16x32_bf16 v[44:47], v[60:63], v[236:239], v[44:47]
  v_and_b32_dpp v58, v81, v4 quad_perm:[2,2,2,2] row_mask:0xf bank_mask:0xf
  v_and_b32_dpp v59, v81, v5 quad_perm:[2,2,2,2] row_mask:0xf bank_mask:0xf
  s_waitcnt vmcnt(19)
  v_mfma_f32_16x16x32_bf16 v[40:43], v[50:53], v[240:243], v[40:43]
  v_mfma_f32_16x16x32_bf16 v[44:47], v[48:51], v[240:243], v[44:47]
  v_and_b32_dpp v62, v81, v4 quad_perm:[3,3,3,3] row_mask:0xf bank_mask:0xf
  v_and_b32_dpp v63, v81, v5 quad_perm:[3,3,3,3] row_mask:0xf bank_mask:0xf
  s_waitcnt vmcnt(18)
  v_mfma_f32_16x16x32_bf16 v[40:43], v[54:57], v[244:247], v[40:43]
  v_mfma_f32_16x16x32_bf16 v[44:47], v[52:55], v[244:247], v[44:47]
  v_and_b32_dpp v50, v82, v4 quad_perm:[0,0,0,0] row_mask:0xf bank_mask:0xf
  v_and_b32_dpp v51, v82, v5 quad_perm:[0,0,0,0] row_mask:0xf bank_mask:0xf
  s_waitcnt vmcnt(17)
  v_mfma_f32_16x16x32_bf16 v[40:43], v[58:61], v[248:251], v[40:43]
  v_mfma_f32_16x16x32_bf16 v[44:47], v[56:59], v[248:251], v[44:47]
  v_and_b32_dpp v54, v82, v4 quad_perm:[1,1,1,1] row_mask:0xf bank_mask:0xf
  v_and_b32_dpp v55, v82, v5 quad_perm:[1,1,1,1] row_mask:0xf bank_mask:0xf
  s_waitcnt vmcnt(16)
  v_mfma_f32_16x16x32_bf16 v[40:43], v[62:65], v[252:255], v[40:43]
  v_mfma_f32_16x16x32_bf16 v[44:47], v[60:63], v[252:255], v[44:47]
  v_and_b32_dpp v58, v82, v4 quad_perm:[2,2,2,2] row_mask:0xf bank_mask:0xf
  v_and_b32_dpp v59, v82, v5 quad_perm:[2,2,2,2] row_mask:0xf bank_mask:0xf
  s_waitcnt vmcnt(15)
  v_mfma_f32_16x16x32_bf16 v[40:43], v[50:53], v[96:99], v[40:43]
  v_mfma_f32_16x16x32_bf16 v[44:47], v[48:51], v[96:99], v[44:47]
  v_and_b32_dpp v62, v82, v4 quad_perm:[3,3,3,3] row_mask:0xf bank_mask:0xf
  v_and_b32_dpp v63, v82, v5 quad_perm:[3,3,3,3] row_mask:0xf bank_mask:0xf
  s_waitcnt vmcnt(14)
  v_mfma_f32_16x16x32_bf16 v[40:43], v[54:57], v[100:103], v[40:43]
  v_mfma_f32_16x16x32_bf16 v[44:47], v[52:55], v[100:103], v[44:47]
  v_and_b32_dpp v50, v83, v4 quad_perm:[0,0,0,0] row_mask:0xf bank_mask:0xf
  v_and_b32_dpp v51, v83, v5 quad_perm:[0,0,0,0] row_mask:0xf bank_mask:0xf
  s_waitcnt vmcnt(13)
  v_mfma_f32_16x16x32_bf16 v[40:43], v[58:61], v[104:107], v[40:43]
  v_mfma_f32_16x16x32_bf16 v[44:47], v[56:59], v[104:107], v[44:47]
  v_and_b32_dpp v54, v83, v4 quad_perm:[1,1,1,1] row_mask:0xf bank_mask:0xf
  v_and_b32_dpp v55, v83, v5 quad_perm:[1,1,1,1] row_mask:0xf bank_mask:0xf
  s_waitcnt vmcnt(12)
  v_mfma_f32_16x16x32_bf16 v[40:43], v[62:65], v[108:111], v[40:43]
  v_mfma_f32_16x16x32_bf16 v[44:47], v[60:63], v[108:111], v[44:47]
  v_and_b32_dpp v58, v83, v4 quad_perm:[2,2,2,2] row_mask:0xf bank_mask:0xf
  v_and_b32_dpp v59, v83, v5 quad_perm:[2,2,2,2] row_mask:0xf bank_mask:0xf
  s_waitcnt vmcnt(11)
  v_mfma_f32_16x16x32_bf16 v[40:43], v[50:53], v[112:115], v[40:43]
  v_mfma_f32_16x16x32_bf16 v[44:47], v[48:51], v[112:115], v[44:47]
  v_and_b32_dpp v62, v83, v4 quad_perm:[3,3,3,3] row_mask:0xf bank_mask:0xf
  v_and_b32_dpp v63, v83, v5 quad_perm:[3,3,3,3] row_mask:0xf bank_mask:0xf
  s_waitcnt vmcnt(10)
  v_mfma_f32_16x16x32_bf16 v[40:43], v[54:57], v[116:119], v[40:43]
  v_mfma_f32_16x16x32_bf16 v[44:47], v[52:55], v[116:119], v[44:47]
  v_and_b32_dpp v50, v84, v4 quad_perm:[0,0,0,0] row_mask:0xf bank_mask:0xf
  v_and_b32_dpp v51, v84, v5 quad_perm:[0,0,0,0] row_mask:0xf bank_mask:0xf
  s_waitcnt vmcnt(9)
  v_mfma_f32_16x16x32_bf16 v[40:43], v[58:61], v[120:123], v[40:43]
  v_mfma_f32_16x16x32_bf16 v[44:47], v[56:59], v[120:123], v[44:47]
  v_and_b32_dpp v54, v84, v4 quad_perm:[1,1,1,1] row_mask:0xf bank_mask:0xf
  v_and_b32_dpp v55, v84, v5 quad_perm:[1,1,1,1] row_mask:0xf bank_mask:0xf
  s_waitcnt vmcnt(8)
  v_mfma_f32_16x16x32_bf16 v[40:43], v[62:65], v[124:127], v[40:43]
  v_mfma_f32_16x16x32_bf16 v[44:47], v[60:63], v[124:127], v[44:47]
  v_and_b32_dpp v58, v84, v4 quad_perm:[2,2,2,2] row_mask:0xf bank_mask:0xf
  v_and_b32_dpp v59, v84, v5 quad_perm:[2,2,2,2] row_mask:0xf bank_mask:0xf
  s_waitcnt vmcnt(7)
  v_mfma_f32_16x16x32_bf16 v[40:43], v[50:53], v[128:131], v[40:43]
  v_mfma_f32_16x16x32_bf16 v[44:47], v[48:51], v[128:131], v[44:47]
  v_and_b32_dpp v62, v84, v4 quad_perm:[3,3,3,3] row_mask:0xf bank_mask:0xf
  v_and_b32_dpp v63, v84, v5 quad_perm:[3,3,3,3] row_mask:0xf bank_mask:0xf
  s_waitcnt vmcnt(6)
  v_mfma_f32_16x16x32_bf16 v[40:43], v[54:57], v[132:135], v[40:43]
  v_mfma_f32_16x16x32_bf16 v[44:47], v[52:55], v[132:135], v[44:47]
  v_and_b32_dpp v50, v85, v4 quad_perm:[0,0,0,0] row_mask:0xf bank_mask:0xf
  v_and_b32_dpp v51, v85, v5 quad_perm:[0,0,0,0] row_mask:0xf bank_mask:0xf
  s_waitcnt vmcnt(5)
  v_mfma_f32_16x16x32_bf16 v[40:43], v[58:61], v[136:139], v[40:43]
  v_mfma_f32_16x16x32_bf16 v[44:47], v[56:59], v[136:139], v[44:47]
  v_and_b32_dpp v54, v85, v4 quad_perm:[1,1,1,1] row_mask:0xf bank_mask:0xf
  v_and_b32_dpp v55, v85, v5 quad_perm:[1,1,1,1] row_mask:0xf bank_mask:0xf
  s_waitcnt vmcnt(4)
  v_mfma_f32_16x16x32_bf16 v[40:43], v[62:65], v[140:143], v[40:43]
  v_mfma_f32_16x16x32_bf16 v[44:47], v[60:63], v[140:143], v[44:47]
  v_and_b32_dpp v58, v85, v4 quad_perm:[2,2,2,2] row_mask:0xf bank_mask:0xf
  v_and_b32_dpp v59, v85, v5 quad_perm:[2,2,2,2] row_mask:0xf bank_mask:0xf
  s_waitcnt vmcnt(3)
  v_mfma_f32_16x16x32_bf16 v[40:43], v[50:53], v[144:147], v[40:43]
  v_mfma_f32_16x16x32_bf16 v[44:47], v[48:51], v[144:147], v[44:47]
  v_and_b32_dpp v62, v85, v4 quad_perm:[3,3,3,3] row_mask:0xf bank_mask:0xf
  v_and_b32_dpp v63, v85, v5 quad_perm:[3,3,3,3] row_mask:0xf bank_mask:0xf
  s_waitcnt vmcnt(2)
  v_mfma_f32_16x16x32_bf16 v[40:43], v[54:57], v[148:151], v[40:43]
  v_mfma_f32_16x16x32_bf16 v[44:47], v[52:55], v[148:151], v[44:47]
  s_waitcnt vmcnt(1)
  v_mfma_f32_16x16x32_bf16 v[40:43], v[58:61], v[152:155], v[40:43]
  v_mfma_f32_16x16x32_bf16 v[44:47], v[56:59], v[152:155], v[44:47]
  s_cmp_ge_u32 s3, 4
  s_waitcnt vmcnt(0)
  v_mfma_f32_16x16x32_bf16 v[40:43], v[62:65], v[156:159], v[40:43]
  v_mfma_f32_16x16x32_bf16 v[44:47], v[60:63], v[156:159], v[44:47]
  s_cbranch_scc0 L_slow
  s_nop 5
  ds_write_b128 v11, v[40:43] offset:2048
  ds_write_b128 v11, v[44:47] offset:2064
  s_waitcnt lgkmcnt(0)
  s_barrier
  s_branch L_sdone
L_slow:
  s_add_u32 s52, s18, s11
  s_addc_u32 s53, s19, 0
  s_mov_b32 s54, 8388608
  s_add_u32 s12, s20, s11
  s_addc_u32 s13, s21, 0
  s_mov_b32 s14, 8388608
  s_mov_b32 s56, 0
  s_cmp_lg_u32 s3, 0
  s_cbranch_scc1 L_getrange
  v_cmp_gt_u32 s[40:41], 12, v1
  v_lshlrev_b32 v9, 7, v1
Llw_8:
  ds_read_b32 v36, v12 offset:8
  s_waitcnt lgkmcnt(0)
  v_cmp_eq_u32 vcc, 0, v36
  s_nop 0
  s_cmp_eq_u64 vcc, 0
  s_cbranch_scc1 Llg_9
  s_sleep 2
  s_branch Llw_8
Llg_9:
  s_memrealtime s[38:39]
  s_lshl_b32 s9, s6, 7
  v_mov_b32 v38, s9
  v_mov_b32 v37, v8
  s_waitcnt lgkmcnt(0)
  v_mov_b32 v36, s38
  s_mov_b64 exec, 1
  buffer_store_dwordx2 v[36:37], v38, s[44:47], s43 offen sc1
  s_mov_b64 exec, -1
  s_sleep 8
  s_mov_b32 s58, s42
  s_mov_b64 s[74:75], 4095
  s_mov_b64 exec, s[74:75]
Lpoll_10:
  buffer_load_dwordx2 v[36:37], v9, s[44:47], s43 offen sc1
  s_waitcnt vmcnt(0)
  v_cmpx_eq_u32 vcc, v37, v8
  s_nop 0
  s_andn2_b64 s[74:75], s[74:75], exec
  s_cbranch_scc0 Lpdone_11
  s_mov_b64 exec, s[74:75]
  s_sleep 10
  s_sub_u32 s58, s58, 1
  s_cbranch_scc0 Lpoll_10
Lpdone_11:
  s_mov_b64 exec, -1
  s_nop 1
  v_sub_u32 v36, v36, v8
  v_cvt_f32_i32 v36, v36
  v_cndmask_b32 v36, 0, v36, s[40:41]
  v_mov_b32 v37, v36
  s_nop 1
  v_add_f32_dpp v37, v37, v37 quad_perm:[1,0,3,2] row_mask:0xf bank_mask:0xf
  s_nop 1
  v_add_f32_dpp v37, v37, v37 quad_perm:[2,3,0,1] row_mask:0xf bank_mask:0xf
  s_nop 1
  v_add_f32_dpp v37, v37, v37 row_half_mirror row_mask:0xf bank_mask:0xf
  s_nop 1
  v_add_f32_dpp v37, v37, v37 row_mirror row_mask:0xf bank_mask:0xf
  v_mul_f32 v37, 0x3daaaaab, v37
  v_sub_f32 v36, v37, v36
  v_mul_f32 v36, 0x403851ec, v36
  v_add_f32 v36, 0x442aaaab, v36
  v_max_f32 v36, 0, v36
  v_min_f32 v36, 0x49000000, v36
  v_cvt_u32_f32 v36, v36
  v_cndmask_b32 v36, 0, v36, s[40:41]
  v_mov_b32 v37, v36
  s_nop 1
  v_add_u32_dpp v37, v37, v37 quad_perm:[1,0,3,2] row_mask:0xf bank_mask:0xf
  s_nop 1
  v_add_u32_dpp v37, v37, v37 quad_perm:[2,3,0,1] row_mask:0xf bank_mask:0xf
  s_nop 1
  v_add_u32_dpp v37, v37, v37 row_half_mirror row_mask:0xf bank_mask:0xf
  s_nop 1
  v_add_u32_dpp v37, v37, v37 row_mirror row_mask:0xf bank_mask:0xf
  v_add_u32_dpp v36, v36, v36 row_shr:1 row_mask:0xf bank_mask:0xf bound_ctrl:0
  s_nop 1
  v_add_u32_dpp v36, v36, v36 row_shr:2 row_mask:0xf bank_mask:0xf bound_ctrl:0
  s_nop 1
  v_add_u32_dpp v36, v36, v36 row_shr:4 row_mask:0xf bank_mask:0xf bound_ctrl:0
  s_nop 1
  v_add_u32_dpp v36, v36, v36 row_shr:8 row_mask:0xf bank_mask:0xf bound_ctrl:0
  v_cvt_f32_u32 v37, v37
  v_cvt_f32_u32 v36, v36
  v_rcp_f32 v37, v37
  v_mul_f32 v36, 0x43000000, v36
  v_fma_f32 v36, v36, v37, 0.5
  v_cvt_u32_f32 v36, v36
  v_min_u32 v36, 128, v36
  v_mov_b32 v37, 0
  s_nop 1
  v_mov_b32_dpp v37, v36 row_shr:1 row_mask:0xf bank_mask:0xf bound_ctrl:0
  v_readlane_b32 s41, v36, s6
  v_readlane_b32 s40, v37, s6
  s_cmp_eq_u32 s6, 11
  s_cselect_b32 s41, 128, s41
  s_lshl_b32 s41, s41, 8
  s_or_b32 s40, s40, s41
  s_bitset1_b32 s40, 31
  v_mov_b32 v36, s40
  ds_write_b32 v12, v36 offset:12
L_getrange:
Llw_12:
  ds_read_b32 v36, v12 offset:12
  s_waitcnt lgkmcnt(0)
  v_cmp_eq_u32 vcc, 0, v36
  s_nop 0
  s_cmp_eq_u64 vcc, 0
  s_cbranch_scc1 Llg_13
  s_sleep 4
  s_branch Llw_12
Llg_13:
  v_readfirstlane_b32 s40, v36
  s_nop 0
  s_bfe_u32 s41, s40, 0x80008
  s_and_b32 s40, s40, 0xff
  s_add_u32 s40, s40, s3
L_dyn:
  s_cmp_ge_u32 s40, s41
  s_cbranch_scc1 L_dynexit
  s_sub_u32 s10, s41, s40
  s_add_u32 s10, s10, 3
  s_lshr_b32 s10, s10, 2
  s_min_u32 s10, s10, 5
  s_sub_u32 s10, 5, s10
  s_cmp_gt_u32 s10, 0
  s_cbranch_scc1 Lnoiss_14
  s_mul_i32 s9, s40, 16384
  s_lshr_b32 s9, s9, 16
  s_mul_i32 s9, s9, 80
  s_add_u32 s9, s9, 80
  s_min_u32 s9, s9, 1920
  s_add_u32 s9, s9, s40
  s_lshl_b32 s9, s9, 12
  s_add_u32 s40, s40, 4
  buffer_load_dwordx4 v[96:99], v2, s[52:55], s9 offen offset:0 nt
  buffer_load_dwordx4 v[100:103], v2, s[52:55], s9 offen offset:128 nt
  buffer_load_dwordx4 v[104:107], v2, s[52:55], s9 offen offset:2048 nt
  buffer_load_dwordx4 v[108:111], v2, s[52:55], s9 offen offset:2176 nt
  buffer_load_dwordx4 v[112:115], v3, s[12:15], s9 offen offset:0 nt
  buffer_load_dwordx4 v[116:119], v3, s[12:15], s9 offen offset:1024 nt
  buffer_load_dwordx4 v[120:123], v3, s[12:15], s9 offen offset:2048 nt
  buffer_load_dwordx4 v[124:127], v3, s[12:15], s9 offen offset:3072 nt
Lnoiss_14:
  s_cmp_gt_u32 s10, 1
  s_cbranch_scc1 Lnoiss_15
  s_mul_i32 s9, s40, 16384
  s_lshr_b32 s9, s9, 16
  s_mul_i32 s9, s9, 80
  s_add_u32 s9, s9, 80
  s_min_u32 s9, s9, 1920
  s_add_u32 s9, s9, s40
  s_lshl_b32 s9, s9, 12
  s_add_u32 s40, s40, 4
  buffer_load_dwordx4 v[128:131], v2, s[52:55], s9 offen offset:0 nt
  buffer_load_dwordx4 v[132:135], v2, s[52:55], s9 offen offset:128 nt
  buffer_load_dwordx4 v[136:139], v2, s[52:55], s9 offen offset:2048 nt
  buffer_load_dwordx4 v[140:143], v2, s[52:55], s9 offen offset:2176 nt
  buffer_load_dwordx4 v[144:147], v3, s[12:15], s9 offen offset:0 nt
  buffer_load_dwordx4 v[148:151], v3, s[12:15], s9 offen offset:1024 nt
  buffer_load_dwordx4 v[152:155], v3, s[12:15], s9 offen offset:2048 nt
  buffer_load_dwordx4 v[156:159], v3, s[12:15], s9 offen offset:3072 nt
Lnoiss_15:
  s_cmp_gt_u32 s10, 2
  s_cbranch_scc1 Lnoiss_16
  s_mul_i32 s9, s40, 16384
  s_lshr_b32 s9, s9, 16
  s_mul_i32 s9, s9, 80
  s_add_u32 s9, s9, 80
  s_min_u32 s9, s9, 1920
  s_add_u32 s9, s9, s40
  s_lshl_b32 s9, s9, 12
  s_add_u32 s40, s40, 4
  buffer_load_dwordx4 v[160:163], v2, s[52:55], s9 offen offset:0 nt
  buffer_load_dwordx4 v[164:167], v2, s[52:55], s9 offen offset:128 nt
  buffer_load_dwordx4 v[168:171], v2, s[52:55], s9 offen offset:2048 nt
  buffer_load_dwordx4 v[172:175], v2, s[52:55], s9 offen offset:2176 nt
  buffer_load_dwordx4 v[176:179], v3, s[12:15], s9 offen offset:0 nt
  buffer_load_dwordx4 v[180:183], v3, s[12:15], s9 offen offset:1024 nt
  buffer_load_dwordx4 v[184:187], v3, s[12:15], s9 offen offset:2048 nt
  buffer_load_dwordx4 v[188:191], v3, s[12:15], s9 offen offset:3072 nt
Lnoiss_16:
  s_cmp_gt_u32 s10, 3
  s_cbranch_scc1 Lnoiss_17
  s_mul_i32 s9, s40, 16384
  s_lshr_b32 s9, s9, 16
  s_mul_i32 s9, s9, 80
  s_add_u32 s9, s9, 80
  s_min_u32 s9, s9, 1920
  s_add_u32 s9, s9, s40
  s_lshl_b32 s9, s9, 12
  s_add_u32 s40, s40, 4
  buffer_load_dwordx4 v[192:195], v2, s[52:55], s9 offen offset:0 nt
  buffer_load_dwordx4 v[196:199], v2, s[52:55], s9 offen offset:128 nt
  buffer_load_dwordx4 v[200:203], v2, s[52:55], s9 offen offset:2048 nt
  buffer_load_dwordx4 v[204:207], v2, s[52:55], s9 offen offset:2176 nt
  buffer_load_dwordx4 v[208:211], v3, s[12:15], s9 offen offset:0 nt
  buffer_load_dwordx4 v[212:215], v3, s[12:15], s9 offen offset:1024 nt
  buffer_load_dwordx4 v[216:219], v3, s[12:15], s9 offen offset:2048 nt
  buffer_load_dwordx4 v[220:223], v3, s[12:15], s9 offen offset:3072 nt
Lnoiss_17:
  s_cmp_gt_u32 s10, 4
  s_cbranch_scc1 Lnoiss_18
  s_mul_i32 s9, s40, 16384
  s_lshr_b32 s9, s9, 16
  s_mul_i32 s9, s9, 80
  s_add_u32 s9, s9, 80
  s_min_u32 s9, s9, 1920
  s_add_u32 s9, s9, s40
  s_lshl_b32 s9, s9, 12
  s_add_u32 s40, s40, 4
  buffer_load_dwordx4 v[224:227], v2, s[52:55], s9 offen offset:0 nt
  buffer_load_dwordx4 v[228:231], v2, s[52:55], s9 offen offset:128 nt
  buffer_load_dwordx4 v[232:235], v2, s[52:55], s9 offen offset:2048 nt
  buffer_load_dwordx4 v[236:239], v2, s[52:55], s9 offen offset:2176 nt
  buffer_load_dwordx4 v[240:243], v3, s[12:15], s9 offen offset:0 nt
  buffer_load_dwordx4 v[244:247], v3, s[12:15], s9 offen offset:1024 nt
  buffer_load_dwordx4 v[248:251], v3, s[12:15], s9 offen offset:2048 nt
  buffer_load_dwordx4 v[252:255], v3, s[12:15], s9 offen offset:3072 nt
Lnoiss_18:
  s_cmp_gt_u32 s10, 0
  s_cbranch_scc1 Lnoproc_19
  s_waitcnt vmcnt(36)
  v_mfma_f32_16x16x32_bf16 v[32:35], v[96:99], v[16:19], 0
  v_mfma_f32_16x16x32_bf16 v[32:35], v[100:103], v[20:23], v[32:35]
  v_mfma_f32_16x16x32_bf16 v[32:35], v[104:107], v[24:27], v[32:35]
  v_mfma_f32_16x16x32_bf16 v[32:35], v[108:111], v[28:31], v[32:35]
  s_nop 7
  v_add_f32_dpp v36, v33, v32 quad_perm:[1,0,3,2] row_mask:0xf bank_mask:0xf
  v_add_f32_dpp v37, v34, v35 quad_perm:[1,0,3,2] row_mask:0xf bank_mask:0xf
  v_cndmask_b32 v36, v36, v37, s[60:61]
  v_cvt_pk_bf16_f32 v36, v36, v36
  v_and_b32 v36, 0xffff0000, v36
  v_mul_f32 v36, s57, v36
  v_cvt_pk_bf16_f32 v36, v36, v36
  v_and_b32 v36, 0xffff0000, v36
  v_sub_f32 v37, v36, v6
  v_cmp_lt_f32 vcc, s56, v37
  s_nop 0
  s_cmp_lg_u64 vcc, 0
  s_cbranch_scc1 Lrare_20
Lback_21:
  v_fma_f32 v36, v36, s59, -v15
  v_exp_f32 v36, v36
  s_nop 0
  v_add_f32 v7, v7, v36
  v_cvt_pk_bf16_f32 v36, v36, v36
  s_nop 1
  v_and_b32_dpp v50, v36, v4 quad_perm:[0,0,0,0] row_mask:0xf bank_mask:0xf
  v_and_b32_dpp v51, v36, v5 quad_perm:[0,0,0,0] row_mask:0xf bank_mask:0xf
  v_and_b32_dpp v54, v36, v4 quad_perm:[1,1,1,1] row_mask:0xf bank_mask:0xf
  v_and_b32_dpp v55, v36, v5 quad_perm:[1,1,1,1] row_mask:0xf bank_mask:0xf
  v_and_b32_dpp v58, v36, v4 quad_perm:[2,2,2,2] row_mask:0xf bank_mask:0xf
  v_and_b32_dpp v59, v36, v5 quad_perm:[2,2,2,2] row_mask:0xf bank_mask:0xf
  v_and_b32_dpp v62, v36, v4 quad_perm:[3,3,3,3] row_mask:0xf bank_mask:0xf
  v_and_b32_dpp v63, v36, v5 quad_perm:[3,3,3,3] row_mask:0xf bank_mask:0xf
  s_waitcnt vmcnt(32)
  v_mfma_f32_16x16x32_bf16 v[40:43], v[50:53], v[112:115], v[40:43]
  v_mfma_f32_16x16x32_bf16 v[44:47], v[48:51], v[112:115], v[44:47]
  v_mfma_f32_16x16x32_bf16 v[40:43], v[54:57], v[116:119], v[40:43]
  v_mfma_f32_16x16x32_bf16 v[44:47], v[52:55], v[116:119], v[44:47]
  v_mfma_f32_16x16x32_bf16 v[40:43], v[58:61], v[120:123], v[40:43]
  v_mfma_f32_16x16x32_bf16 v[44:47], v[56:59], v[120:123], v[44:47]
  v_mfma_f32_16x16x32_bf16 v[40:43], v[62:65], v[124:127], v[40:43]
  v_mfma_f32_16x16x32_bf16 v[44:47], v[60:63], v[124:127], v[44:47]
Lnoproc_19:
  s_cmp_gt_u32 s10, 1
  s_cbranch_scc1 Lnoproc_22
  s_waitcnt vmcnt(28)
  v_mfma_f32_16x16x32_bf16 v[32:35], v[128:131], v[16:19], 0
  v_mfma_f32_16x16x32_bf16 v[32:35], v[132:135], v[20:23], v[32:35]
  v_mfma_f32_16x16x32_bf16 v[32:35], v[136:139], v[24:27], v[32:35]
  v_mfma_f32_16x16x32_bf16 v[32:35], v[140:143], v[28:31], v[32:35]
  s_nop 7
  v_add_f32_dpp v36, v33, v32 quad_perm:[1,0,3,2] row_mask:0xf bank_mask:0xf
  v_add_f32_dpp v37, v34, v35 quad_perm:[1,0,3,2] row_mask:0xf bank_mask:0xf
  v_cndmask_b32 v36, v36, v37, s[60:61]
  v_cvt_pk_bf16_f32 v36, v36, v36
  v_and_b32 v36, 0xffff0000, v36
  v_mul_f32 v36, s57, v36
  v_cvt_pk_bf16_f32 v36, v36, v36
  v_and_b32 v36, 0xffff0000, v36
  v_sub_f32 v37, v36, v6
  v_cmp_lt_f32 vcc, s56, v37
  s_nop 0
  s_cmp_lg_u64 vcc, 0
  s_cbranch_scc1 Lrare_23
Lback_24:
  v_fma_f32 v36, v36, s59, -v15
  v_exp_f32 v36, v36
  s_nop 0
  v_add_f32 v7, v7, v36
  v_cvt_pk_bf16_f32 v36, v36, v36
  s_nop 1
  v_and_b32_dpp v50, v36, v4 quad_perm:[0,0,0,0] row_mask:0xf bank_mask:0xf
  v_and_b32_dpp v51, v36, v5 quad_perm:[0,0,0,0] row_mask:0xf bank_mask:0xf
  v_and_b32_dpp v54, v36, v4 quad_perm:[1,1,1,1] row_mask:0xf bank_mask:0xf
  v_and_b32_dpp v55, v36, v5 quad_perm:[1,1,1,1] row_mask:0xf bank_mask:0xf
  v_and_b32_dpp v58, v36, v4 quad_perm:[2,2,2,2] row_mask:0xf bank_mask:0xf
  v_and_b32_dpp v59, v36, v5 quad_perm:[2,2,2,2] row_mask:0xf bank_mask:0xf
  v_and_b32_dpp v62, v36, v4 quad_perm:[3,3,3,3] row_mask:0xf bank_mask:0xf
  v_and_b32_dpp v63, v36, v5 quad_perm:[3,3,3,3] row_mask:0xf bank_mask:0xf
  s_waitcnt vmcnt(24)
  v_mfma_f32_16x16x32_bf16 v[40:43], v[50:53], v[144:147], v[40:43]
  v_mfma_f32_16x16x32_bf16 v[44:47], v[48:51], v[144:147], v[44:47]
  v_mfma_f32_16x16x32_bf16 v[40:43], v[54:57], v[148:151], v[40:43]
  v_mfma_f32_16x16x32_bf16 v[44:47], v[52:55], v[148:151], v[44:47]
  v_mfma_f32_16x16x32_bf16 v[40:43], v[58:61], v[152:155], v[40:43]
  v_mfma_f32_16x16x32_bf16 v[44:47], v[56:59], v[152:155], v[44:47]
  v_mfma_f32_16x16x32_bf16 v[40:43], v[62:65], v[156:159], v[40:43]
  v_mfma_f32_16x16x32_bf16 v[44:47], v[60:63], v[156:159], v[44:47]
Lnoproc_22:
  s_cmp_gt_u32 s10, 2
  s_cbranch_scc1 Lnoproc_25
  s_waitcnt vmcnt(20)
  v_mfma_f32_16x16x32_bf16 v[32:35], v[160:163], v[16:19], 0
  v_mfma_f32_16x16x32_bf16 v[32:35], v[164:167], v[20:23], v[32:35]
  v_mfma_f32_16x16x32_bf16 v[32:35], v[168:171], v[24:27], v[32:35]
  v_mfma_f32_16x16x32_bf16 v[32:35], v[172:175], v[28:31], v[32:35]
  s_nop 7
  v_add_f32_dpp v36, v33, v32 quad_perm:[1,0,3,2] row_mask:0xf bank_mask:0xf
  v_add_f32_dpp v37, v34, v35 quad_perm:[1,0,3,2] row_mask:0xf bank_mask:0xf
  v_cndmask_b32 v36, v36, v37, s[60:61]
  v_cvt_pk_bf16_f32 v36, v36, v36
  v_and_b32 v36, 0xffff0000, v36
  v_mul_f32 v36, s57, v36
  v_cvt_pk_bf16_f32 v36, v36, v36
  v_and_b32 v36, 0xffff0000, v36
  v_sub_f32 v37, v36, v6
  v_cmp_lt_f32 vcc, s56, v37
  s_nop 0
  s_cmp_lg_u64 vcc, 0
  s_cbranch_scc1 Lrare_26
Lback_27:
  v_fma_f32 v36, v36, s59, -v15
  v_exp_f32 v36, v36
  s_nop 0
  v_add_f32 v7, v7, v36
  v_cvt_pk_bf16_f32 v36, v36, v36
  s_nop 1
  v_and_b32_dpp v50, v36, v4 quad_perm:[0,0,0,0] row_mask:0xf bank_mask:0xf
  v_and_b32_dpp v51, v36, v5 quad_perm:[0,0,0,0] row_mask:0xf bank_mask:0xf
  v_and_b32_dpp v54, v36, v4 quad_perm:[1,1,1,1] row_mask:0xf bank_mask:0xf
  v_and_b32_dpp v55, v36, v5 quad_perm:[1,1,1,1] row_mask:0xf bank_mask:0xf
  v_and_b32_dpp v58, v36, v4 quad_perm:[2,2,2,2] row_mask:0xf bank_mask:0xf
  v_and_b32_dpp v59, v36, v5 quad_perm:[2,2,2,2] row_mask:0xf bank_mask:0xf
  v_and_b32_dpp v62, v36, v4 quad_perm:[3,3,3,3] row_mask:0xf bank_mask:0xf
  v_and_b32_dpp v63, v36, v5 quad_perm:[3,3,3,3] row_mask:0xf bank_mask:0xf
  s_waitcnt vmcnt(16)
  v_mfma_f32_16x16x32_bf16 v[40:43], v[50:53], v[176:179], v[40:43]
  v_mfma_f32_16x16x32_bf16 v[44:47], v[48:51], v[176:179], v[44:47]
  v_mfma_f32_16x16x32_bf16 v[40:43], v[54:57], v[180:183], v[40:43]
  v_mfma_f32_16x16x32_bf16 v[44:47], v[52:55], v[180:183], v[44:47]
  v_mfma_f32_16x16x32_bf16 v[40:43], v[58:61], v[184:187], v[40:43]
  v_mfma_f32_16x16x32_bf16 v[44:47], v[56:59], v[184:187], v[44:47]
  v_mfma_f32_16x16x32_bf16 v[40:43], v[62:65], v[188:191], v[40:43]
  v_mfma_f32_16x16x32_bf16 v[44:47], v[60:63], v[188:191], v[44:47]
Lnoproc_25:
  s_cmp_gt_u32 s10, 3
  s_cbranch_scc1 Lnoproc_28
  s_waitcnt vmcnt(12)
  v_mfma_f32_16x16x32_bf16 v[32:35], v[192:195], v[16:19], 0
  v_mfma_f32_16x16x32_bf16 v[32:35], v[196:199], v[20:23], v[32:35]
  v_mfma_f32_16x16x32_bf16 v[32:35], v[200:203], v[24:27], v[32:35]
  v_mfma_f32_16x16x32_bf16 v[32:35], v[204:207], v[28:31], v[32:35]
  s_nop 7
  v_add_f32_dpp v36, v33, v32 quad_perm:[1,0,3,2] row_mask:0xf bank_mask:0xf
  v_add_f32_dpp v37, v34, v35 quad_perm:[1,0,3,2] row_mask:0xf bank_mask:0xf
  v_cndmask_b32 v36, v36, v37, s[60:61]
  v_cvt_pk_bf16_f32 v36, v36, v36
  v_and_b32 v36, 0xffff0000, v36
  v_mul_f32 v36, s57, v36
  v_cvt_pk_bf16_f32 v36, v36, v36
  v_and_b32 v36, 0xffff0000, v36
  v_sub_f32 v37, v36, v6
  v_cmp_lt_f32 vcc, s56, v37
  s_nop 0
  s_cmp_lg_u64 vcc, 0
  s_cbranch_scc1 Lrare_29
Lback_30:
  v_fma_f32 v36, v36, s59, -v15
  v_exp_f32 v36, v36
  s_nop 0
  v_add_f32 v7, v7, v36
  v_cvt_pk_bf16_f32 v36, v36, v36
  s_nop 1
  v_and_b32_dpp v50, v36, v4 quad_perm:[0,0,0,0] row_mask:0xf bank_mask:0xf
  v_and_b32_dpp v51, v36, v5 quad_perm:[0,0,0,0] row_mask:0xf bank_mask:0xf
  v_and_b32_dpp v54, v36, v4 quad_perm:[1,1,1,1] row_mask:0xf bank_mask:0xf
  v_and_b32_dpp v55, v36, v5 quad_perm:[1,1,1,1] row_mask:0xf bank_mask:0xf
  v_and_b32_dpp v58, v36, v4 quad_perm:[2,2,2,2] row_mask:0xf bank_mask:0xf
  v_and_b32_dpp v59, v36, v5 quad_perm:[2,2,2,2] row_mask:0xf bank_mask:0xf
  v_and_b32_dpp v62, v36, v4 quad_perm:[3,3,3,3] row_mask:0xf bank_mask:0xf
  v_and_b32_dpp v63, v36, v5 quad_perm:[3,3,3,3] row_mask:0xf bank_mask:0xf
  s_waitcnt vmcnt(8)
  v_mfma_f32_16x16x32_bf16 v[40:43], v[50:53], v[208:211], v[40:43]
  v_mfma_f32_16x16x32_bf16 v[44:47], v[48:51], v[208:211], v[44:47]
  v_mfma_f32_16x16x32_bf16 v[40:43], v[54:57], v[212:215], v[40:43]
  v_mfma_f32_16x16x32_bf16 v[44:47], v[52:55], v[212:215], v[44:47]
  v_mfma_f32_16x16x32_bf16 v[40:43], v[58:61], v[216:219], v[40:43]
  v_mfma_f32_16x16x32_bf16 v[44:47], v[56:59], v[216:219], v[44:47]
  v_mfma_f32_16x16x32_bf16 v[40:43], v[62:65], v[220:223], v[40:43]
  v_mfma_f32_16x16x32_bf16 v[44:47], v[60:63], v[220:223], v[44:47]
Lnoproc_28:
  s_cmp_gt_u32 s10, 4
  s_cbranch_scc1 Lnoproc_31
  s_waitcnt vmcnt(4)
  v_mfma_f32_16x16x32_bf16 v[32:35], v[224:227], v[16:19], 0
  v_mfma_f32_16x16x32_bf16 v[32:35], v[228:231], v[20:23], v[32:35]
  v_mfma_f32_16x16x32_bf16 v[32:35], v[232:235], v[24:27], v[32:35]
  v_mfma_f32_16x16x32_bf16 v[32:35], v[236:239], v[28:31], v[32:35]
  s_nop 7
  v_add_f32_dpp v36, v33, v32 quad_perm:[1,0,3,2] row_mask:0xf bank_mask:0xf
  v_add_f32_dpp v37, v34, v35 quad_perm:[1,0,3,2] row_mask:0xf bank_mask:0xf
  v_cndmask_b32 v36, v36, v37, s[60:61]
  v_cvt_pk_bf16_f32 v36, v36, v36
  v_and_b32 v36, 0xffff0000, v36
  v_mul_f32 v36, s57, v36
  v_cvt_pk_bf16_f32 v36, v36, v36
  v_and_b32 v36, 0xffff0000, v36
  v_sub_f32 v37, v36, v6
  v_cmp_lt_f32 vcc, s56, v37
  s_nop 0
  s_cmp_lg_u64 vcc, 0
  s_cbranch_scc1 Lrare_32
Lback_33:
  v_fma_f32 v36, v36, s59, -v15
  v_exp_f32 v36, v36
  s_nop 0
  v_add_f32 v7, v7, v36
  v_cvt_pk_bf16_f32 v36, v36, v36
  s_nop 1
  v_and_b32_dpp v50, v36, v4 quad_perm:[0,0,0,0] row_mask:0xf bank_mask:0xf
  v_and_b32_dpp v51, v36, v5 quad_perm:[0,0,0,0] row_mask:0xf bank_mask:0xf
  v_and_b32_dpp v54, v36, v4 quad_perm:[1,1,1,1] row_mask:0xf bank_mask:0xf
  v_and_b32_dpp v55, v36, v5 quad_perm:[1,1,1,1] row_mask:0xf bank_mask:0xf
  v_and_b32_dpp v58, v36, v4 quad_perm:[2,2,2,2] row_mask:0xf bank_mask:0xf
  v_and_b32_dpp v59, v36, v5 quad_perm:[2,2,2,2] row_mask:0xf bank_mask:0xf
  v_and_b32_dpp v62, v36, v4 quad_perm:[3,3,3,3] row_mask:0xf bank_mask:0xf
  v_and_b32_dpp v63, v36, v5 quad_perm:[3,3,3,3] row_mask:0xf bank_mask:0xf
  s_waitcnt vmcnt(0)
  v_mfma_f32_16x16x32_bf16 v[40:43], v[50:53], v[240:243], v[40:43]
  v_mfma_f32_16x16x32_bf16 v[44:47], v[48:51], v[240:243], v[44:47]
  v_mfma_f32_16x16x32_bf16 v[40:43], v[54:57], v[244:247], v[40:43]
  v_mfma_f32_16x16x32_bf16 v[44:47], v[52:55], v[244:247], v[44:47]
  v_mfma_f32_16x16x32_bf16 v[40:43], v[58:61], v[248:251], v[40:43]
  v_mfma_f32_16x16x32_bf16 v[44:47], v[56:59], v[248:251], v[44:47]
  v_mfma_f32_16x16x32_bf16 v[40:43], v[62:65], v[252:255], v[40:43]
  v_mfma_f32_16x16x32_bf16 v[44:47], v[60:63], v[252:255], v[44:47]
Lnoproc_31:
  s_branch L_dyn
Lrare_20:
  s_nop 11
  v_mov_b32 v37, v36
  s_nop 1
  v_max_f32_dpp v37, v37, v37 quad_perm:[1,0,3,2] row_mask:0xf bank_mask:0xf
  s_nop 1
  v_max_f32_dpp v37, v37, v37 quad_perm:[2,3,0,1] row_mask:0xf bank_mask:0xf
  v_mov_b32 v38, v37
  s_nop 1
  v_permlane16_swap_b32 v37, v38
  v_max_f32 v37, v37, v38
  v_mov_b32 v38, v37
  s_nop 1
  v_permlane32_swap_b32 v37, v38
  v_max_f32 v37, v37, v38
  v_max_f32 v37, v37, v6
  v_sub_f32 v38, v6, v37
  v_mul_f32 v38, s59, v38
  v_exp_f32 v38, v38
  v_mov_b32 v6, v37
  v_mul_f32 v15, s59, v6
  v_mul_f32 v7, v7, v38
  v_and_b32 v39, 0x30, v1
  ds_bpermute_b32 v38, v39, v38
  s_waitcnt lgkmcnt(0)
  v_mul_f32 v40, v40, v38
  v_mul_f32 v41, v41, v38
  v_mul_f32 v42, v42, v38
  v_mul_f32 v43, v43, v38
  v_mul_f32 v44, v44, v38
  v_mul_f32 v45, v45, v38
  v_mul_f32 v46, v46, v38
  v_mul_f32 v47, v47, v38
  s_nop 3
  s_branch Lback_21
Lrare_23:
  s_nop 11
  v_mov_b32 v37, v36
  s_nop 1
  v_max_f32_dpp v37, v37, v37 quad_perm:[1,0,3,2] row_mask:0xf bank_mask:0xf
  s_nop 1
  v_max_f32_dpp v37, v37, v37 quad_perm:[2,3,0,1] row_mask:0xf bank_mask:0xf
  v_mov_b32 v38, v37
  s_nop 1
  v_permlane16_swap_b32 v37, v38
  v_max_f32 v37, v37, v38
  v_mov_b32 v38, v37
  s_nop 1
  v_permlane32_swap_b32 v37, v38
  v_max_f32 v37, v37, v38
  v_max_f32 v37, v37, v6
  v_sub_f32 v38, v6, v37
  v_mul_f32 v38, s59, v38
  v_exp_f32 v38, v38
  v_mov_b32 v6, v37
  v_mul_f32 v15, s59, v6
  v_mul_f32 v7, v7, v38
  v_and_b32 v39, 0x30, v1
  ds_bpermute_b32 v38, v39, v38
  s_waitcnt lgkmcnt(0)
  v_mul_f32 v40, v40, v38
  v_mul_f32 v41, v41, v38
  v_mul_f32 v42, v42, v38
  v_mul_f32 v43, v43, v38
  v_mul_f32 v44, v44, v38
  v_mul_f32 v45, v45, v38
  v_mul_f32 v46, v46, v38
  v_mul_f32 v47, v47, v38
  s_nop 3
  s_branch Lback_24
Lrare_26:
  s_nop 11
  v_mov_b32 v37, v36
  s_nop 1
  v_max_f32_dpp v37, v37, v37 quad_perm:[1,0,3,2] row_mask:0xf bank_mask:0xf
  s_nop 1
  v_max_f32_dpp v37, v37, v37 quad_perm:[2,3,0,1] row_mask:0xf bank_mask:0xf
  v_mov_b32 v38, v37
  s_nop 1
  v_permlane16_swap_b32 v37, v38
  v_max_f32 v37, v37, v38
  v_mov_b32 v38, v37
  s_nop 1
  v_permlane32_swap_b32 v37, v38
  v_max_f32 v37, v37, v38
  v_max_f32 v37, v37, v6
  v_sub_f32 v38, v6, v37
  v_mul_f32 v38, s59, v38
  v_exp_f32 v38, v38
  v_mov_b32 v6, v37
  v_mul_f32 v15, s59, v6
  v_mul_f32 v7, v7, v38
  v_and_b32 v39, 0x30, v1
  ds_bpermute_b32 v38, v39, v38
  s_waitcnt lgkmcnt(0)
  v_mul_f32 v40, v40, v38
  v_mul_f32 v41, v41, v38
  v_mul_f32 v42, v42, v38
  v_mul_f32 v43, v43, v38
  v_mul_f32 v44, v44, v38
  v_mul_f32 v45, v45, v38
  v_mul_f32 v46, v46, v38
  v_mul_f32 v47, v47, v38
  s_nop 3
  s_branch Lback_27
Lrare_29:
  s_nop 11
  v_mov_b32 v37, v36
  s_nop 1
  v_max_f32_dpp v37, v37, v37 quad_perm:[1,0,3,2] row_mask:0xf bank_mask:0xf
  s_nop 1
  v_max_f32_dpp v37, v37, v37 quad_perm:[2,3,0,1] row_mask:0xf bank_mask:0xf
  v_mov_b32 v38, v37
  s_nop 1
  v_permlane16_swap_b32 v37, v38
  v_max_f32 v37, v37, v38
  v_mov_b32 v38, v37
  s_nop 1
  v_permlane32_swap_b32 v37, v38
  v_max_f32 v37, v37, v38
  v_max_f32 v37, v37, v6
  v_sub_f32 v38, v6, v37
  v_mul_f32 v38, s59, v38
  v_exp_f32 v38, v38
  v_mov_b32 v6, v37
  v_mul_f32 v15, s59, v6
  v_mul_f32 v7, v7, v38
  v_and_b32 v39, 0x30, v1
  ds_bpermute_b32 v38, v39, v38
  s_waitcnt lgkmcnt(0)
  v_mul_f32 v40, v40, v38
  v_mul_f32 v41, v41, v38
  v_mul_f32 v42, v42, v38
  v_mul_f32 v43, v43, v38
  v_mul_f32 v44, v44, v38
  v_mul_f32 v45, v45, v38
  v_mul_f32 v46, v46, v38
  v_mul_f32 v47, v47, v38
  s_nop 3
  s_branch Lback_30
Lrare_32:
  s_nop 11
  v_mov_b32 v37, v36
  s_nop 1
  v_max_f32_dpp v37, v37, v37 quad_perm:[1,0,3,2] row_mask:0xf bank_mask:0xf
  s_nop 1
  v_max_f32_dpp v37, v37, v37 quad_perm:[2,3,0,1] row_mask:0xf bank_mask:0xf
  v_mov_b32 v38, v37
  s_nop 1
  v_permlane16_swap_b32 v37, v38
  v_max_f32 v37, v37, v38
  v_mov_b32 v38, v37
  s_nop 1
  v_permlane32_swap_b32 v37, v38
  v_max_f32 v37, v37, v38
  v_max_f32 v37, v37, v6
  v_sub_f32 v38, v6, v37
  v_mul_f32 v38, s59, v38
  v_exp_f32 v38, v38
  v_mov_b32 v6, v37
  v_mul_f32 v15, s59, v6
  v_mul_f32 v7, v7, v38
  v_and_b32 v39, 0x30, v1
  ds_bpermute_b32 v38, v39, v38
  s_waitcnt lgkmcnt(0)
  v_mul_f32 v40, v40, v38
  v_mul_f32 v41, v41, v38
  v_mul_f32 v42, v42, v38
  v_mul_f32 v43, v43, v38
  v_mul_f32 v44, v44, v38
  v_mul_f32 v45, v45, v38
  v_mul_f32 v46, v46, v38
  v_mul_f32 v47, v47, v38
  s_nop 3
  s_branch Lback_33
L_dynexit:
  s_nop 7
  v_add_f32_dpp v7, v7, v7 quad_perm:[1,0,3,2] row_mask:0xf bank_mask:0xf
  s_nop 1
  v_add_f32_dpp v7, v7, v7 quad_perm:[2,3,0,1] row_mask:0xf bank_mask:0xf
  v_mov_b32 v9, v7
  s_nop 1
  v_permlane16_swap_b32 v7, v9
  v_add_f32 v7, v7, v9
  v_mov_b32 v9, v7
  s_nop 1
  v_permlane32_swap_b32 v7, v9
  v_add_f32 v7, v7, v9
  v_bfe_u32 v9, v1, 2, 2
  v_lshlrev_b32 v9, 5, v9
  s_lshl_b32 s9, s3, 2
  v_add_u32 v9, s9, v9
  ds_write_b32 v9, v6 offset:1280
  ds_write_b32 v9, v7 offset:1408
  ds_write_b128 v11, v[40:43] offset:2048
  ds_write_b128 v11, v[44:47] offset:2064
  s_lshl_b32 s9, s3, 5
  v_mov_b32 v17, s9
  s_waitcnt lgkmcnt(0)
  s_mov_b64 exec, 1
  ds_add_u32 v12, v13 offset:4
  s_mov_b64 exec, -1
Lcntwait_34:
  ds_read_b32 v16, v12 offset:4
  s_waitcnt lgkmcnt(0)
  v_cmp_ne_u32 vcc, 8, v16
  s_nop 0
  s_cmp_eq_u64 vcc, 0
  s_cbranch_scc1 Lcntgo_35
  s_sleep 2
  s_branch Lcntwait_34
Lcntgo_35:
  ds_read_b128 v[88:91], v17 offset:1280
  ds_read_b128 v[92:95], v17 offset:1296
  ds_read_b128 v[20:23], v17 offset:1408
  ds_read_b128 v[24:27], v17 offset:1424
  ds_read_b64 v[32:33], v10 offset:2048
  ds_read_b64 v[34:35], v10 offset:4096
  ds_read_b64 v[36:37], v10 offset:6144
  ds_read_b64 v[38:39], v10 offset:8192
  s_waitcnt lgkmcnt(0)
  v_max3_f32 v16, v88, v89, v90
  v_max3_f32 v16, v16, v91, v92
  v_max3_f32 v16, v16, v93, v94
  v_max_f32 v16, v16, v95
  v_mov_b32 v18, 0
  v_sub_f32 v88, v88, v16
  v_mul_f32 v88, s59, v88
  v_exp_f32 v88, v88
  s_nop 0
  v_fmac_f32 v18, v88, v20
  v_sub_f32 v89, v89, v16
  v_mul_f32 v89, s59, v89
  v_exp_f32 v89, v89
  s_nop 0
  v_fmac_f32 v18, v89, v21
  v_sub_f32 v90, v90, v16
  v_mul_f32 v90, s59, v90
  v_exp_f32 v90, v90
  s_nop 0
  v_fmac_f32 v18, v90, v22
  v_sub_f32 v91, v91, v16
  v_mul_f32 v91, s59, v91
  v_exp_f32 v91, v91
  s_nop 0
  v_fmac_f32 v18, v91, v23
  v_sub_f32 v92, v92, v16
  v_mul_f32 v92, s59, v92
  v_exp_f32 v92, v92
  s_nop 0
  v_fmac_f32 v18, v92, v24
  v_sub_f32 v93, v93, v16
  v_mul_f32 v93, s59, v93
  v_exp_f32 v93, v93
  s_nop 0
  v_fmac_f32 v18, v93, v25
  v_sub_f32 v94, v94, v16
  v_mul_f32 v94, s59, v94
  v_exp_f32 v94, v94
  s_nop 0
  v_fmac_f32 v18, v94, v26
  v_sub_f32 v95, v95, v16
  v_mul_f32 v95, s59, v95
  v_exp_f32 v95, v95
  s_nop 0
  v_fmac_f32 v18, v95, v27
  v_log_f32 v14, v18
  v_rcp_f32 v18, v18
  v_fmac_f32 v14, s59, v16
  v_mov_b32 v13, v8
  v_mov_b32 v15, v8
  v_mul_f32 v88, v88, v18
  v_mul_f32 v89, v89, v18
  v_mul_f32 v90, v90, v18
  v_mul_f32 v91, v91, v18
  v_mul_f32 v92, v92, v18
  v_mul_f32 v93, v93, v18
  v_mul_f32 v94, v94, v18
  v_mul_f32 v95, v95, v18
  v_mul_f32 v28, v32, v88
  v_mul_f32 v29, v33, v88
  v_fmac_f32 v28, v34, v89
  v_fmac_f32 v29, v35, v89
  v_fmac_f32 v28, v36, v90
  v_fmac_f32 v29, v37, v90
  v_fmac_f32 v28, v38, v91
  v_fmac_f32 v29, v39, v91
  s_barrier
  ds_read_b64 v[32:33], v10 offset:10240
  ds_read_b64 v[34:35], v10 offset:12288
  ds_read_b64 v[36:37], v10 offset:14336
  ds_read_b64 v[38:39], v10 offset:16384
  s_waitcnt lgkmcnt(0)
  v_fmac_f32 v28, v32, v92
  v_fmac_f32 v29, v33, v92
  v_mul_f32 v30, v34, v93
  v_mul_f32 v31, v35, v93
  v_fmac_f32 v28, v36, v94
  v_fmac_f32 v29, v37, v94
  v_fmac_f32 v30, v38, v95
  v_fmac_f32 v31, v39, v95
  v_pk_add_f32 v[28:29], v[28:29], v[30:31]
  v_cvt_pk_bf16_f32 v12, v28, v29
  buffer_store_dwordx4 v[12:15], v3, s[44:47], s7 offen sc1
L_sdone:
  s_endpgm
L_role:
  s_nop 3
  s_memrealtime s[66:67]
  v_and_b32 v6, 15, v1
  v_lshlrev_b32 v6, 3, v6
  v_lshrrev_b32 v7, 4, v1
  v_lshrrev_b32 v9, 5, v1
  v_lshlrev_b32 v12, 10, v9
  v_and_b32 v10, 31, v1
  v_lshl_add_u32 v12, v10, 2, v12
  s_lshl_b32 s4, s3, 7
  v_add_u32 v12, s4, v12
  v_lshlrev_b32 v17, 5, v1
  v_mov_b32 v11, 0
  s_mov_b32 s72, 0x05040100
  s_mov_b32 s73, 0x07060302
  s_waitcnt lgkmcnt(0)
  s_mov_b32 s44, s40
  s_mov_b32 s45, s41
  s_mov_b32 s48, s38
  s_mov_b32 s49, s39
  s_or_b32 s4, s2, s3
  s_cmp_lg_u32 s4, 0
  s_cbranch_scc1 Lnononce_36
  s_or_b32 s66, s66, 1
  v_mov_b32 v9, s66
  s_mov_b64 exec, 1
  buffer_store_dword v9, v11, s[48:51], 0 offen sc1
  s_mov_b64 exec, -1
Lnononce_36:
  s_mov_b32 s52, s32
  s_mov_b32 s53, s33
  s_mov_b32 s54, 2048
  s_mov_b32 s55, 0x20000
  buffer_load_dword v2, v12, s[52:55], 0 offen
  s_cmp_ge_u32 s2, 16
  s_cbranch_scc1 Lnomodw_37
  s_mov_b32 s52, s34
  s_mov_b32 s53, s35
  s_mov_b32 s54, 3145728
  s_mov_b32 s55, 0x20000
  s_mul_i32 s4, s3, 393216
  s_lshl_b32 s5, s2, 7
  s_add_u32 s4, s4, s5
  v_mul_u32_u24 v9, 98304, v7
  v_add_u32 v9, v9, v6
  buffer_load_dwordx2 v[192:193], v9, s[52:55], s4 offen nt
  s_add_u32 s4, s4, 6144
  buffer_load_dwordx2 v[194:195], v9, s[52:55], s4 offen nt
  s_add_u32 s4, s4, 6144
  buffer_load_dwordx2 v[196:197], v9, s[52:55], s4 offen nt
  s_add_u32 s4, s4, 6144
  buffer_load_dwordx2 v[198:199], v9, s[52:55], s4 offen nt
  s_add_u32 s4, s4, 6144
  buffer_load_dwordx2 v[200:201], v9, s[52:55], s4 offen nt
  s_add_u32 s4, s4, 6144
  buffer_load_dwordx2 v[202:203], v9, s[52:55], s4 offen nt
  s_add_u32 s4, s4, 6144
  buffer_load_dwordx2 v[204:205], v9, s[52:55], s4 offen nt
  s_add_u32 s4, s4, 6144
  buffer_load_dwordx2 v[206:207], v9, s[52:55], s4 offen nt
  s_add_u32 s4, s4, 6144
  buffer_load_dwordx2 v[208:209], v9, s[52:55], s4 offen nt
  s_add_u32 s4, s4, 6144
  buffer_load_dwordx2 v[210:211], v9, s[52:55], s4 offen nt
  s_add_u32 s4, s4, 6144
  buffer_load_dwordx2 v[212:213], v9, s[52:55], s4 offen nt
  s_add_u32 s4, s4, 6144
  buffer_load_dwordx2 v[214:215], v9, s[52:55], s4 offen nt
  s_add_u32 s4, s4, 6144
  buffer_load_dwordx2 v[216:217], v9, s[52:55], s4 offen nt
  s_add_u32 s4, s4, 6144
  buffer_load_dwordx2 v[218:219], v9, s[52:55], s4 offen nt
  s_add_u32 s4, s4, 6144
  buffer_load_dwordx2 v[220:221], v9, s[52:55], s4 offen nt
  s_add_u32 s4, s4, 6144
  buffer_load_dwordx2 v[222:223], v9, s[52:55], s4 offen nt
  buffer_load_dword v8, v11, s[48:51], 0 offen sc1
  s_barrier
Lnomodw_37:
  s_mov_b32 s12, s16
  s_mov_b32 s13, s17
  s_mov_b32 s14, 2048
  s_mov_b32 s15, 0x20000
  buffer_load_dword v21, v12, s[12:15], 0 offen
  buffer_load_dwordx4 v[24:27], v17, s[12:15], 0 offen
  buffer_load_dwordx4 v[28:31], v17, s[12:15], 0 offen offset:16
  s_mov_b32 s52, s22
  s_mov_b32 s53, s23
  s_mov_b32 s54, 4194304
  s_mov_b32 s55, 0x20000
  s_mul_i32 s4, s3, 524288
  s_lshl_b32 s5, s2, 7
  s_add_u32 s4, s4, s5
  v_mul_u32_u24 v9, 131072, v7
  v_add_u32 v9, v9, v6
  buffer_load_dwordx2 v[224:225], v9, s[52:55], s4 offen nt
  s_add_u32 s4, s4, 8192
  buffer_load_dwordx2 v[226:227], v9, s[52:55], s4 offen nt
  s_add_u32 s4, s4, 8192
  buffer_load_dwordx2 v[228:229], v9, s[52:55], s4 offen nt
  s_add_u32 s4, s4, 8192
  buffer_load_dwordx2 v[230:231], v9, s[52:55], s4 offen nt
  s_add_u32 s4, s4, 8192
  buffer_load_dwordx2 v[232:233], v9, s[52:55], s4 offen nt
  s_add_u32 s4, s4, 8192
  buffer_load_dwordx2 v[234:235], v9, s[52:55], s4 offen nt
  s_add_u32 s4, s4, 8192
  buffer_load_dwordx2 v[236:237], v9, s[52:55], s4 offen nt
  s_add_u32 s4, s4, 8192
  buffer_load_dwordx2 v[238:239], v9, s[52:55], s4 offen nt
  s_add_u32 s4, s4, 8192
  buffer_load_dwordx2 v[240:241], v9, s[52:55], s4 offen nt
  s_add_u32 s4, s4, 8192
  buffer_load_dwordx2 v[242:243], v9, s[52:55], s4 offen nt
  s_add_u32 s4, s4, 8192
  buffer_load_dwordx2 v[244:245], v9, s[52:55], s4 offen nt
  s_add_u32 s4, s4, 8192
  buffer_load_dwordx2 v[246:247], v9, s[52:55], s4 offen nt
  s_add_u32 s4, s4, 8192
  buffer_load_dwordx2 v[248:249], v9, s[52:55], s4 offen nt
  s_add_u32 s4, s4, 8192
  buffer_load_dwordx2 v[250:251], v9, s[52:55], s4 offen nt
  s_add_u32 s4, s4, 8192
  buffer_load_dwordx2 v[252:253], v9, s[52:55], s4 offen nt
  s_add_u32 s4, s4, 8192
  buffer_load_dwordx2 v[254:255], v9, s[52:55], s4 offen nt
  v_lshlrev_b32 v13, 3, v1
  s_lshl_b32 s4, s3, 9
  v_lshlrev_b32 v14, 2, v1
  v_add_u32 v14, s4, v14
  v_bfe_u32 v15, v1, 2, 1
  v_lshlrev_b32 v15, 7, v15
  v_lshl_add_u32 v15, v7, 5, v15
  v_add_u32 v15, s4, v15
  s_lshl_b32 s4, s3, 10
  v_lshlrev_b32 v16, 4, v1
  v_add_u32 v16, s4, v16
  v_lshrrev_b32 v9, 5, v1
  v_mul_u32_u24 v18, 12288, v9
  v_and_b32 v10, 31, v1
  v_lshl_add_u32 v18, v10, 3, v18
  s_lshl_b32 s4, s3, 8
  v_add_u32 v19, s4, v18
  s_cmp_ge_u32 s2, 16
  s_cbranch_scc1 Lnomod_38
  s_waitcnt vmcnt(36)
  v_lshlrev_b32 v22, 16, v2
  v_and_b32 v23, 0xffff0000, v2
  v_mul_f32 v9, 0xbfb8aa00, v22
  v_mul_f32 v60, 0xb6a407db, v22
  v_mul_f32 v10, 0xbfb8aa00, v23
  v_mul_f32 v61, 0xb6a407db, v23
  v_exp_f32 v9, v9
  v_exp_f32 v10, v10
  v_fma_f32 v9, v9, v60, v9
  v_fma_f32 v10, v10, v61, v10
  v_min_f32 v9, 0x7f7fffff, v9
  v_min_f32 v10, 0x7f7fffff, v10
  v_add_f32 v9, 1.0, v9
  v_add_f32 v10, 1.0, v10
  v_rcp_f32 v60, v9
  v_rcp_f32 v61, v10
  v_mul_f32 v62, v22, v60
  v_mul_f32 v63, v23, v61
  v_fma_f32 v22, -v62, v9, v22
  v_fma_f32 v23, -v63, v10, v23
  v_fma_f32 v22, v22, v60, v62
  v_fma_f32 v23, v23, v61, v63
  v_cvt_pk_bf16_f32 v22, v22, v23
  ds_write_b32 v14, v22 offset:0
  ds_read_b128 v[64:67], v15 offset:0
  ds_read_b128 v[68:71], v15 offset:16
  s_waitcnt vmcnt(28)
  v_perm_b32 v128, v194, v192, s72
  v_perm_b32 v132, v194, v192, s73
  v_perm_b32 v136, v195, v193, s72
  v_perm_b32 v140, v195, v193, s73
  v_perm_b32 v129, v198, v196, s72
  v_perm_b32 v133, v198, v196, s73
  v_perm_b32 v137, v199, v197, s72
  v_perm_b32 v141, v199, v197, s73
  v_perm_b32 v130, v202, v200, s72
  v_perm_b32 v134, v202, v200, s73
  v_perm_b32 v138, v203, v201, s72
  v_perm_b32 v142, v203, v201, s73
  v_perm_b32 v131, v206, v204, s72
  v_perm_b32 v135, v206, v204, s73
  v_perm_b32 v139, v207, v205, s72
  v_perm_b32 v143, v207, v205, s73
  s_waitcnt lgkmcnt(0)
  v_mfma_f32_16x16x32_bf16 v[80:83], v[64:67], v[128:131], 0
  v_mfma_f32_16x16x32_bf16 v[84:87], v[64:67], v[132:135], 0
  v_mfma_f32_16x16x32_bf16 v[88:91], v[64:67], v[136:139], 0
  v_mfma_f32_16x16x32_bf16 v[92:95], v[64:67], v[140:143], 0
  s_waitcnt vmcnt(19)
  v_perm_b32 v144, v210, v208, s72
  v_perm_b32 v148, v210, v208, s73
  v_perm_b32 v152, v211, v209, s72
  v_perm_b32 v156, v211, v209, s73
  v_perm_b32 v145, v214, v212, s72
  v_perm_b32 v149, v214, v212, s73
  v_perm_b32 v153, v215, v213, s72
  v_perm_b32 v157, v215, v213, s73
  v_perm_b32 v146, v218, v216, s72
  v_perm_b32 v150, v218, v216, s73
  v_perm_b32 v154, v219, v217, s72
  v_perm_b32 v158, v219, v217, s73
  v_perm_b32 v147, v222, v220, s72
  v_perm_b32 v151, v222, v220, s73
  v_perm_b32 v155, v223, v221, s72
  v_perm_b32 v159, v223, v221, s73
  v_mfma_f32_16x16x32_bf16 v[80:83], v[68:71], v[144:147], v[80:83]
  v_mfma_f32_16x16x32_bf16 v[84:87], v[68:71], v[148:151], v[84:87]
  v_mfma_f32_16x16x32_bf16 v[88:91], v[68:71], v[152:155], v[88:91]
  v_mfma_f32_16x16x32_bf16 v[92:95], v[68:71], v[156:159], v[92:95]
  v_add_u32 v20, 8192, v16
  s_nop 4
  ds_write2_b32 v20, v80, v84 offset0:0 offset1:1
  s_nop 0
  ds_write2_b32 v20, v88, v92 offset0:2 offset1:3
  s_waitcnt lgkmcnt(0)
  s_barrier
  s_cmp_lg_u32 s3, 0
  s_cbranch_scc1 Lmodpub_39
  ds_read_b64 v[96:97], v13 offset:8192
  ds_read_b64 v[98:99], v13 offset:9216
  ds_read_b64 v[100:101], v13 offset:10240
  ds_read_b64 v[102:103], v13 offset:11264
  ds_read_b64 v[104:105], v13 offset:12288
  ds_read_b64 v[106:107], v13 offset:13312
  ds_read_b64 v[108:109], v13 offset:14336
  ds_read_b64 v[110:111], v13 offset:15360
  v_cmp_eq_u32 vcc, 0, v8
  s_nop 0
  s_cmp_eq_u64 vcc, 0
  s_cbranch_scc1 Lnonceok_40
  s_mov_b32 s58, s42
  s_mov_b64 s[74:75], -1
Lpoll_41:
  buffer_load_dword v8, v11, s[48:51], 0 offen sc1
  s_waitcnt vmcnt(0)
  v_cmpx_ne_u32 vcc, 0, v8
  s_nop 0
  s_andn2_b64 s[74:75], s[74:75], exec
  s_cbranch_scc0 Lpdone_42
  s_mov_b64 exec, s[74:75]
  s_sub_u32 s58, s58, 1
  s_cbranch_scc0 Lpoll_41
Lpdone_42:
  s_mov_b64 exec, -1
  s_nop 1
Lnonceok_40:
  s_lshl_b32 s4, s2, 8
  s_waitcnt lgkmcnt(0)
  v_pk_add_f32 v[96:97], v[96:97], v[98:99]
  v_pk_add_f32 v[100:101], v[100:101], v[102:103]
  v_pk_add_f32 v[104:105], v[104:105], v[106:107]
  v_pk_add_f32 v[108:109], v[108:109], v[110:111]
  v_pk_add_f32 v[96:97], v[96:97], v[100:101]
  v_pk_add_f32 v[104:105], v[104:105], v[108:109]
  v_pk_add_f32 v[22:23], v[96:97], v[104:105]
  v_cvt_pk_bf16_f32 v22, v22, v23
  v_mov_b32 v23, v8
  buffer_store_dwordx2 v[22:23], v18, s[44:47], s4 offen offset:0 sc1
Lmodpub_39:
  s_nop 1
Lnomod_38:
  s_waitcnt vmcnt(16)
  v_lshlrev_b32 v32, 16, v24
  v_and_b32 v33, 0xffff0000, v24
  v_lshlrev_b32 v34, 16, v25
  v_and_b32 v35, 0xffff0000, v25
  v_lshlrev_b32 v36, 16, v26
  v_and_b32 v37, 0xffff0000, v26
  v_lshlrev_b32 v38, 16, v27
  v_and_b32 v39, 0xffff0000, v27
  v_lshlrev_b32 v40, 16, v28
  v_and_b32 v41, 0xffff0000, v28
  v_lshlrev_b32 v42, 16, v29
  v_and_b32 v43, 0xffff0000, v29
  v_lshlrev_b32 v44, 16, v30
  v_and_b32 v45, 0xffff0000, v30
  v_lshlrev_b32 v46, 16, v31
  v_and_b32 v47, 0xffff0000, v31
  v_add_f32 v9, v32, v33
  v_add_f32 v9, v9, v34
  v_add_f32 v9, v9, v35
  v_add_f32 v9, v9, v36
  v_add_f32 v9, v9, v37
  v_add_f32 v9, v9, v38
  v_add_f32 v9, v9, v39
  v_add_f32 v9, v9, v40
  v_add_f32 v9, v9, v41
  v_add_f32 v9, v9, v42
  v_add_f32 v9, v9, v43
  v_add_f32 v9, v9, v44
  v_add_f32 v9, v9, v45
  v_add_f32 v9, v9, v46
  v_add_f32 v9, v9, v47
  s_nop 1
  v_add_f32_dpp v9, v9, v9 quad_perm:[1,0,3,2] row_mask:0xf bank_mask:0xf
  s_nop 1
  v_add_f32_dpp v9, v9, v9 quad_perm:[2,3,0,1] row_mask:0xf bank_mask:0xf
  s_nop 1
  v_add_f32_dpp v9, v9, v9 row_half_mirror row_mask:0xf bank_mask:0xf
  s_nop 1
  v_add_f32_dpp v9, v9, v9 row_mirror row_mask:0xf bank_mask:0xf
  v_mov_b32 v10, v9
  s_nop 1
  v_permlane16_swap_b32 v9, v10
  v_add_f32 v9, v9, v10
  v_mul_f32 v9, 0x3b000000, v9
  v_sub_f32 v32, v32, v9
  v_sub_f32 v33, v33, v9
  v_sub_f32 v34, v34, v9
  v_sub_f32 v35, v35, v9
  v_sub_f32 v36, v36, v9
  v_sub_f32 v37, v37, v9
  v_sub_f32 v38, v38, v9
  v_sub_f32 v39, v39, v9
  v_sub_f32 v40, v40, v9
  v_sub_f32 v41, v41, v9
  v_sub_f32 v42, v42, v9
  v_sub_f32 v43, v43, v9
  v_sub_f32 v44, v44, v9
  v_sub_f32 v45, v45, v9
  v_sub_f32 v46, v46, v9
  v_sub_f32 v47, v47, v9
  v_mul_f32 v3, v32, v32
  v_fmac_f32 v3, v33, v33
  v_fmac_f32 v3, v34, v34
  v_fmac_f32 v3, v35, v35
  v_fmac_f32 v3, v36, v36
  v_fmac_f32 v3, v37, v37
  v_fmac_f32 v3, v38, v38
  v_fmac_f32 v3, v39, v39
  v_fmac_f32 v3, v40, v40
  v_fmac_f32 v3, v41, v41
  v_fmac_f32 v3, v42, v42
  v_fmac_f32 v3, v43, v43
  v_fmac_f32 v3, v44, v44
  v_fmac_f32 v3, v45, v45
  v_fmac_f32 v3, v46, v46
  v_fmac_f32 v3, v47, v47
  s_nop 1
  v_add_f32_dpp v3, v3, v3 quad_perm:[1,0,3,2] row_mask:0xf bank_mask:0xf
  s_nop 1
  v_add_f32_dpp v3, v3, v3 quad_perm:[2,3,0,1] row_mask:0xf bank_mask:0xf
  s_nop 1
  v_add_f32_dpp v3, v3, v3 row_half_mirror row_mask:0xf bank_mask:0xf
  s_nop 1
  v_add_f32_dpp v3, v3, v3 row_mirror row_mask:0xf bank_mask:0xf
  v_mov_b32 v10, v3
  s_nop 1
  v_permlane16_swap_b32 v3, v10
  v_add_f32 v3, v3, v10
  v_mul_f32 v3, 0x3b000000, v3
  v_cvt_pk_bf16_f32 v10, v9, v3
  v_lshlrev_b32 v9, 16, v10
  v_and_b32 v3, 0xffff0000, v10
  v_add_f32 v3, 0x3727c5ac, v3
  v_cvt_pk_bf16_f32 v10, v3, v3
  v_and_b32 v3, 0xffff0000, v10
  v_sqrt_f32 v3, v3
  s_nop 0
  v_cvt_pk_bf16_f32 v10, v3, v3
  v_and_b32 v3, 0xffff0000, v10
  v_rcp_f32 v3, v3
  v_lshlrev_b32 v22, 16, v21
  v_and_b32 v23, 0xffff0000, v21
  v_sub_f32 v22, v22, v9
  v_sub_f32 v23, v23, v9
  v_cvt_pk_bf16_f32 v10, v22, v23
  v_lshlrev_b32 v22, 16, v10
  v_and_b32 v23, 0xffff0000, v10
  v_mul_f32 v22, v22, v3
  v_mul_f32 v23, v23, v3
  v_cvt_pk_bf16_f32 v10, v22, v23
  v_lshlrev_b32 v22, 16, v10
  v_and_b32 v23, 0xffff0000, v10
  s_waitcnt vmcnt(8)
  v_perm_b32 v160, v226, v224, s72
  v_perm_b32 v164, v226, v224, s73
  v_perm_b32 v168, v227, v225, s72
  v_perm_b32 v172, v227, v225, s73
  v_perm_b32 v161, v230, v228, s72
  v_perm_b32 v165, v230, v228, s73
  v_perm_b32 v169, v231, v229, s72
  v_perm_b32 v173, v231, v229, s73
  v_perm_b32 v162, v234, v232, s72
  v_perm_b32 v166, v234, v232, s73
  v_perm_b32 v170, v235, v233, s72
  v_perm_b32 v174, v235, v233, s73
  v_perm_b32 v163, v238, v236, s72
  v_perm_b32 v167, v238, v236, s73
  v_perm_b32 v171, v239, v237, s72
  v_perm_b32 v175, v239, v237, s73
  s_waitcnt vmcnt(0)
  v_perm_b32 v176, v242, v240, s72
  v_perm_b32 v180, v242, v240, s73
  v_perm_b32 v184, v243, v241, s72
  v_perm_b32 v188, v243, v241, s73
  v_perm_b32 v177, v246, v244, s72
  v_perm_b32 v181, v246, v244, s73
  v_perm_b32 v185, v247, v245, s72
  v_perm_b32 v189, v247, v245, s73
  v_perm_b32 v178, v250, v248, s72
  v_perm_b32 v182, v250, v248, s73
  v_perm_b32 v186, v251, v249, s72
  v_perm_b32 v190, v251, v249, s73
  v_perm_b32 v179, v254, v252, s72
  v_perm_b32 v183, v254, v252, s73
  v_perm_b32 v187, v255, v253, s72
  v_perm_b32 v191, v255, v253, s73
  s_mov_b32 s58, s42
  s_mov_b64 s[74:75], -1
Lpoll_43:
  buffer_load_dword v8, v11, s[48:51], 0 offen sc1
  buffer_load_dwordx2 v[24:25], v19, s[44:47], 0 offen offset:0 sc1
  buffer_load_dwordx2 v[26:27], v19, s[44:47], 0 offen offset:2048 sc1
  s_waitcnt vmcnt(0)
  v_cmpx_ne_u32 vcc, 0, v8
  v_cmpx_eq_u32 vcc, v25, v8
  v_cmpx_eq_u32 vcc, v27, v8
  s_nop 0
  s_andn2_b64 s[74:75], s[74:75], exec
  s_cbranch_scc0 Lpdone_44
  s_mov_b64 exec, s[74:75]
  s_sub_u32 s58, s58, 1
  s_cbranch_scc0 Lpoll_43
Lpdone_44:
  s_mov_b64 exec, -1
  s_nop 1
  v_lshlrev_b32 v9, 16, v26
  v_and_b32 v10, 0xffff0000, v26
  v_add_f32 v9, 1.0, v9
  v_add_f32 v10, 1.0, v10
  v_cvt_pk_bf16_f32 v3, v9, v10
  v_lshlrev_b32 v9, 16, v3
  v_and_b32 v10, 0xffff0000, v3
  v_mul_f32 v22, v22, v9
  v_mul_f32 v23, v23, v10
  v_cvt_pk_bf16_f32 v3, v22, v23
  v_lshlrev_b32 v22, 16, v3
  v_and_b32 v23, 0xffff0000, v3
  v_lshlrev_b32 v9, 16, v24
  v_and_b32 v10, 0xffff0000, v24
  v_add_f32 v22, v22, v9
  v_add_f32 v23, v23, v10
  v_cvt_pk_bf16_f32 v22, v22, v23
  ds_write_b32 v14, v22 offset:0
  ds_read_b128 v[64:67], v15 offset:0
  ds_read_b128 v[68:71], v15 offset:16
  s_waitcnt lgkmcnt(0)
  v_mfma_f32_16x16x32_bf16 v[80:83], v[64:67], v[160:163], 0
  v_mfma_f32_16x16x32_bf16 v[84:87], v[64:67], v[164:167], 0
  v_mfma_f32_16x16x32_bf16 v[88:91], v[64:67], v[168:171], 0
  v_mfma_f32_16x16x32_bf16 v[92:95], v[64:67], v[172:175], 0
  v_mfma_f32_16x16x32_bf16 v[80:83], v[68:71], v[176:179], v[80:83]
  v_mfma_f32_16x16x32_bf16 v[84:87], v[68:71], v[180:183], v[84:87]
  v_mfma_f32_16x16x32_bf16 v[88:91], v[68:71], v[184:187], v[88:91]
  v_mfma_f32_16x16x32_bf16 v[92:95], v[68:71], v[188:191], v[92:95]
  v_add_u32 v20, 16384, v16
  s_nop 4
  ds_write2_b32 v20, v80, v84 offset0:0 offset1:1
  s_nop 0
  ds_write2_b32 v20, v88, v92 offset0:2 offset1:3
  s_waitcnt lgkmcnt(0)
  s_barrier
  s_cmp_lg_u32 s3, 0
  s_cbranch_scc1 Lqpub_45
  ds_read_b64 v[96:97], v13 offset:16384
  ds_read_b64 v[98:99], v13 offset:17408
  ds_read_b64 v[100:101], v13 offset:18432
  ds_read_b64 v[102:103], v13 offset:19456
  ds_read_b64 v[104:105], v13 offset:20480
  ds_read_b64 v[106:107], v13 offset:21504
  ds_read_b64 v[108:109], v13 offset:22528
  ds_read_b64 v[110:111], v13 offset:23552
  v_lshrrev_b32 v9, 5, v1
  v_lshlrev_b32 v9, 14, v9
  v_and_b32 v10, 31, v1
  v_lshl_add_u32 v9, v10, 3, v9
  s_lshl_b32 s4, s2, 8
  s_add_u32 s4, s4, 32768
  s_waitcnt lgkmcnt(0)
  v_pk_add_f32 v[96:97], v[96:97], v[98:99]
  v_pk_add_f32 v[100:101], v[100:101], v[102:103]
  v_pk_add_f32 v[104:105], v[104:105], v[106:107]
  v_pk_add_f32 v[108:109], v[108:109], v[110:111]
  v_pk_add_f32 v[96:97], v[96:97], v[100:101]
  v_pk_add_f32 v[104:105], v[104:105], v[108:109]
  v_pk_add_f32 v[22:23], v[96:97], v[104:105]
  v_cvt_pk_bf16_f32 v22, v22, v23
  v_mov_b32 v23, v8
  buffer_store_dwordx2 v[22:23], v9, s[44:47], s4 offen sc1
  s_getreg_b32 s67, hwreg(HW_REG_XCC_ID)
  s_and_b32 s67, s67, 15
  v_mov_b32 v24, s67
  v_mov_b32 v25, v8
  s_lshl_b32 s4, s2, 7
  s_add_u32 s4, s4, 114688
  s_mov_b64 exec, 1
  buffer_store_dwordx2 v[24:25], v11, s[44:47], s4 offen sc1
  s_mov_b64 exec, -1
Lqpub_45:
  s_nop 1
  s_sub_u32 s4, s2, 16
  s_cmp_ge_u32 s4, 32
  s_cbranch_scc1 Lnolate_46
  s_mov_b32 s52, s34
  s_mov_b32 s53, s35
  s_mov_b32 s54, 3145728
  s_mov_b32 s55, 0x20000
  s_mul_i32 s4, s3, 393216
  s_lshl_b32 s5, s2, 7
  s_add_u32 s4, s4, s5
  v_mul_u32_u24 v9, 98304, v7
  v_add_u32 v9, v9, v6
  buffer_load_dwordx2 v[192:193], v9, s[52:55], s4 offen nt
  s_add_u32 s4, s4, 6144
  buffer_load_dwordx2 v[194:195], v9, s[52:55], s4 offen nt
  s_add_u32 s4, s4, 6144
  buffer_load_dwordx2 v[196:197], v9, s[52:55], s4 offen nt
  s_add_u32 s4, s4, 6144
  buffer_load_dwordx2 v[198:199], v9, s[52:55], s4 offen nt
  s_add_u32 s4, s4, 6144
  buffer_load_dwordx2 v[200:201], v9, s[52:55], s4 offen nt
  s_add_u32 s4, s4, 6144
  buffer_load_dwordx2 v[202:203], v9, s[52:55], s4 offen nt
  s_add_u32 s4, s4, 6144
  buffer_load_dwordx2 v[204:205], v9, s[52:55], s4 offen nt
  s_add_u32 s4, s4, 6144
  buffer_load_dwordx2 v[206:207], v9, s[52:55], s4 offen nt
  s_add_u32 s4, s4, 6144
  buffer_load_dwordx2 v[208:209], v9, s[52:55], s4 offen nt
  s_add_u32 s4, s4, 6144
  buffer_load_dwordx2 v[210:211], v9, s[52:55], s4 offen nt
  s_add_u32 s4, s4, 6144
  buffer_load_dwordx2 v[212:213], v9, s[52:55], s4 offen nt
  s_add_u32 s4, s4, 6144
  buffer_load_dwordx2 v[214:215], v9, s[52:55], s4 offen nt
  s_add_u32 s4, s4, 6144
  buffer_load_dwordx2 v[216:217], v9, s[52:55], s4 offen nt
  s_add_u32 s4, s4, 6144
  buffer_load_dwordx2 v[218:219], v9, s[52:55], s4 offen nt
  s_add_u32 s4, s4, 6144
  buffer_load_dwordx2 v[220:221], v9, s[52:55], s4 offen nt
  s_add_u32 s4, s4, 6144
  buffer_load_dwordx2 v[222:223], v9, s[52:55], s4 offen nt
  s_waitcnt vmcnt(16)
  v_lshlrev_b32 v22, 16, v2
  v_and_b32 v23, 0xffff0000, v2
  v_mul_f32 v9, 0xbfb8aa00, v22
  v_mul_f32 v60, 0xb6a407db, v22
  v_mul_f32 v10, 0xbfb8aa00, v23
  v_mul_f32 v61, 0xb6a407db, v23
  v_exp_f32 v9, v9
  v_exp_f32 v10, v10
  v_fma_f32 v9, v9, v60, v9
  v_fma_f32 v10, v10, v61, v10
  v_min_f32 v9, 0x7f7fffff, v9
  v_min_f32 v10, 0x7f7fffff, v10
  v_add_f32 v9, 1.0, v9
  v_add_f32 v10, 1.0, v10
  v_rcp_f32 v60, v9
  v_rcp_f32 v61, v10
  v_mul_f32 v62, v22, v60
  v_mul_f32 v63, v23, v61
  v_fma_f32 v22, -v62, v9, v22
  v_fma_f32 v23, -v63, v10, v23
  v_fma_f32 v22, v22, v60, v62
  v_fma_f32 v23, v23, v61, v63
  v_cvt_pk_bf16_f32 v22, v22, v23
  ds_write_b32 v14, v22 offset:0
  ds_read_b128 v[64:67], v15 offset:0
  ds_read_b128 v[68:71], v15 offset:16
  s_waitcnt vmcnt(8)
  v_perm_b32 v128, v194, v192, s72
  v_perm_b32 v132, v194, v192, s73
  v_perm_b32 v136, v195, v193, s72
  v_perm_b32 v140, v195, v193, s73
  v_perm_b32 v129, v198, v196, s72
  v_perm_b32 v133, v198, v196, s73
  v_perm_b32 v137, v199, v197, s72
  v_perm_b32 v141, v199, v197, s73
  v_perm_b32 v130, v202, v200, s72
  v_perm_b32 v134, v202, v200, s73
  v_perm_b32 v138, v203, v201, s72
  v_perm_b32 v142, v203, v201, s73
  v_perm_b32 v131, v206, v204, s72
  v_perm_b32 v135, v206, v204, s73
  v_perm_b32 v139, v207, v205, s72
  v_perm_b32 v143, v207, v205, s73
  s_waitcnt lgkmcnt(0)
  v_mfma_f32_16x16x32_bf16 v[80:83], v[64:67], v[128:131], 0
  v_mfma_f32_16x16x32_bf16 v[84:87], v[64:67], v[132:135], 0
  v_mfma_f32_16x16x32_bf16 v[88:91], v[64:67], v[136:139], 0
  v_mfma_f32_16x16x32_bf16 v[92:95], v[64:67], v[140:143], 0
  s_waitcnt vmcnt(0)
  v_perm_b32 v144, v210, v208, s72
  v_perm_b32 v148, v210, v208, s73
  v_perm_b32 v152, v211, v209, s72
  v_perm_b32 v156, v211, v209, s73
  v_perm_b32 v145, v214, v212, s72
  v_perm_b32 v149, v214, v212, s73
  v_perm_b32 v153, v215, v213, s72
  v_perm_b32 v157, v215, v213, s73
  v_perm_b32 v146, v218, v216, s72
  v_perm_b32 v150, v218, v216, s73
  v_perm_b32 v154, v219, v217, s72
  v_perm_b32 v158, v219, v217, s73
  v_perm_b32 v147, v222, v220, s72
  v_perm_b32 v151, v222, v220, s73
  v_perm_b32 v155, v223, v221, s72
  v_perm_b32 v159, v223, v221, s73
  v_mfma_f32_16x16x32_bf16 v[80:83], v[68:71], v[144:147], v[80:83]
  v_mfma_f32_16x16x32_bf16 v[84:87], v[68:71], v[148:151], v[84:87]
  v_mfma_f32_16x16x32_bf16 v[88:91], v[68:71], v[152:155], v[88:91]
  v_mfma_f32_16x16x32_bf16 v[92:95], v[68:71], v[156:159], v[92:95]
  v_add_u32 v20, 8192, v16
  s_nop 4
  ds_write2_b32 v20, v80, v84 offset0:0 offset1:1
  s_nop 0
  ds_write2_b32 v20, v88, v92 offset0:2 offset1:3
  s_waitcnt lgkmcnt(0)
  s_barrier
  s_cmp_lg_u32 s3, 0
  s_cbranch_scc1 Lmodpub_47
  ds_read_b64 v[96:97], v13 offset:8192
  ds_read_b64 v[98:99], v13 offset:9216
  ds_read_b64 v[100:101], v13 offset:10240
  ds_read_b64 v[102:103], v13 offset:11264
  ds_read_b64 v[104:105], v13 offset:12288
  ds_read_b64 v[106:107], v13 offset:13312
  ds_read_b64 v[108:109], v13 offset:14336
  ds_read_b64 v[110:111], v13 offset:15360
  s_lshl_b32 s4, s2, 8
  s_waitcnt lgkmcnt(0)
  v_pk_add_f32 v[96:97], v[96:97], v[98:99]
  v_pk_add_f32 v[100:101], v[100:101], v[102:103]
  v_pk_add_f32 v[104:105], v[104:105], v[106:107]
  v_pk_add_f32 v[108:109], v[108:109], v[110:111]
  v_pk_add_f32 v[96:97], v[96:97], v[100:101]
  v_pk_add_f32 v[104:105], v[104:105], v[108:109]
  v_pk_add_f32 v[22:23], v[96:97], v[104:105]
  v_cvt_pk_bf16_f32 v22, v22, v23
  v_mov_b32 v23, v8
  buffer_store_dwordx2 v[22:23], v18, s[44:47], s4 offen offset:0 sc1
Lmodpub_47:
  s_nop 1
Lnolate_46:
  s_lshr_b32 s8, s2, 3
  s_lshl_b32 s8, s8, 2
  s_and_b32 s4, s2, 3
  s_add_u32 s8, s8, s4
  s_lshl_b32 s4, s4, 12
  s_add_u32 s26, s4, 65536
  v_mov_b32 v57, v8
  v_mov_b32 v59, v8
  v_mov_b32 v39, v8
  s_mov_b32 s70, 0x00003f80
  s_mov_b32 s71, 0x3f800000
  v_lshlrev_b32 v18, 4, v1
  s_lshl_b32 s4, s3, 9
  v_add_u32 v18, s4, v18
  s_bitcmp0_b32 s2, 2
  s_cbranch_scc1 L_ffn
  s_mov_b32 s52, s24
  s_mov_b32 s53, s25
  s_mov_b32 s54, 4194304
  s_mov_b32 s55, 0x20000
  s_lshl_b32 s4, s8, 17
  s_lshl_b32 s5, s3, 7
  s_add_u32 s4, s4, s5
  v_mul_u32_u24 v9, 32768, v7
  v_add_u32 v9, v9, v6
  buffer_load_dwordx2 v[192:193], v9, s[52:55], s4 offen nt
  s_add_u32 s4, s4, 1024
  buffer_load_dwordx2 v[194:195], v9, s[52:55], s4 offen nt
  s_add_u32 s4, s4, 1024
  buffer_load_dwordx2 v[196:197], v9, s[52:55], s4 offen nt
  s_add_u32 s4, s4, 1024
  buffer_load_dwordx2 v[198:199], v9, s[52:55], s4 offen nt
  s_add_u32 s4, s4, 1024
  buffer_load_dwordx2 v[200:201], v9, s[52:55], s4 offen nt
  s_add_u32 s4, s4, 1024
  buffer_load_dwordx2 v[202:203], v9, s[52:55], s4 offen nt
  s_add_u32 s4, s4, 1024
  buffer_load_dwordx2 v[204:205], v9, s[52:55], s4 offen nt
  s_add_u32 s4, s4, 1024
  buffer_load_dwordx2 v[206:207], v9, s[52:55], s4 offen nt
  s_add_u32 s4, s4, 1024
  buffer_load_dwordx2 v[208:209], v9, s[52:55], s4 offen nt
  s_add_u32 s4, s4, 1024
  buffer_load_dwordx2 v[210:211], v9, s[52:55], s4 offen nt
  s_add_u32 s4, s4, 1024
  buffer_load_dwordx2 v[212:213], v9, s[52:55], s4 offen nt
  s_add_u32 s4, s4, 1024
  buffer_load_dwordx2 v[214:215], v9, s[52:55], s4 offen nt
  s_add_u32 s4, s4, 1024
  buffer_load_dwordx2 v[216:217], v9, s[52:55], s4 offen nt
  s_add_u32 s4, s4, 1024
  buffer_load_dwordx2 v[218:219], v9, s[52:55], s4 offen nt
  s_add_u32 s4, s4, 1024
  buffer_load_dwordx2 v[220:221], v9, s[52:55], s4 offen nt
  s_add_u32 s4, s4, 1024
  buffer_load_dwordx2 v[222:223], v9, s[52:55], s4 offen nt
  s_add_u32 s4, s4, 1024
  buffer_load_dwordx2 v[224:225], v9, s[52:55], s4 offen nt
  s_add_u32 s4, s4, 1024
  buffer_load_dwordx2 v[226:227], v9, s[52:55], s4 offen nt
  s_add_u32 s4, s4, 1024
  buffer_load_dwordx2 v[228:229], v9, s[52:55], s4 offen nt
  s_add_u32 s4, s4, 1024
  buffer_load_dwordx2 v[230:231], v9, s[52:55], s4 offen nt
  s_add_u32 s4, s4, 1024
  buffer_load_dwordx2 v[232:233], v9, s[52:55], s4 offen nt
  s_add_u32 s4, s4, 1024
  buffer_load_dwordx2 v[234:235], v9, s[52:55], s4 offen nt
  s_add_u32 s4, s4, 1024
  buffer_load_dwordx2 v[236:237], v9, s[52:55], s4 offen nt
  s_add_u32 s4, s4, 1024
  buffer_load_dwordx2 v[238:239], v9, s[52:55], s4 offen nt
  s_add_u32 s4, s4, 1024
  buffer_load_dwordx2 v[240:241], v9, s[52:55], s4 offen nt
  s_add_u32 s4, s4, 1024
  buffer_load_dwordx2 v[242:243], v9, s[52:55], s4 offen nt
  s_add_u32 s4, s4, 1024
  buffer_load_dwordx2 v[244:245], v9, s[52:55], s4 offen nt
  s_add_u32 s4, s4, 1024
  buffer_load_dwordx2 v[246:247], v9, s[52:55], s4 offen nt
  s_add_u32 s4, s4, 1024
  buffer_load_dwordx2 v[248:249], v9, s[52:55], s4 offen nt
  s_add_u32 s4, s4, 1024
  buffer_load_dwordx2 v[250:251], v9, s[52:55], s4 offen nt
  s_add_u32 s4, s4, 1024
  buffer_load_dwordx2 v[252:253], v9, s[52:55], s4 offen nt
  s_add_u32 s4, s4, 1024
  buffer_load_dwordx2 v[254:255], v9, s[52:55], s4 offen nt
  s_and_b32 s4, s3, 3
  s_lshl_b32 s10, s8, 2
  s_add_u32 s10, s10, s4
  s_lshr_b32 s43, s10, 1
  s_lshr_b32 s4, s43, 3
  s_lshl_b32 s4, s4, 7
  s_and_b32 s5, s43, 3
  s_lshl_b32 s5, s5, 5
  s_add_u32 s4, s4, s5
  s_bfe_u32 s5, s43, 0x10002
  s_lshl_b32 s56, s5, 10
  s_add_u32 s56, s56, s4
  s_mul_i32 s57, s5, 12288
  s_lshl_b32 s4, s4, 1
  s_add_u32 s57, s57, s4
  s_and_b32 s4, s10, 1
  s_lshl_b32 s4, s4, 2
  v_and_b32 v11, 3, v1
  v_lshrrev_b32 v9, 2, v1
  v_lshlrev_b32 v17, 13, v9
  v_lshl_add_u32 v17, v11, 3, v17
  v_add_u32 v11, s4, v11
  v_lshlrev_b32 v54, 3, v11
  v_lshlrev_b32 v55, 2, v11
  s_lshl_b32 s4, s10, 5
  s_add_u32 s32, s4, 524288
  s_add_u32 s33, s32, 4096
  s_lshl_b32 s4, s43, 6
  s_add_u32 s23, s26, s4
  s_add_u32 s23, s23, 0x4000
  s_add_u32 s57, s57, 10240
  s_mov_b32 s58, s42
  s_mov_b64 s[74:75], -1
Lpoll_48:
  buffer_load_dwordx2 v[22:23], v54, s[44:47], s57 offen sc1
  s_waitcnt vmcnt(0)
  v_cmpx_eq_u32 vcc, v23, v8
  s_nop 0
  s_andn2_b64 s[74:75], s[74:75], exec
  s_cbranch_scc0 Lpdone_49
  s_mov_b64 exec, s[74:75]
  s_sleep 4
  s_sub_u32 s58, s58, 1
  s_cbranch_scc0 Lpoll_48
Lpdone_49:
  s_mov_b64 exec, -1
  s_nop 1
  v_lshlrev_b32 v36, 16, v22
  v_and_b32 v37, 0xffff0000, v22
  v_perm_b32 v128, v194, v192, s72
  v_perm_b32 v132, v194, v192, s73
  v_perm_b32 v136, v195, v193, s72
  v_perm_b32 v140, v195, v193, s73
  v_perm_b32 v129, v198, v196, s72
  v_perm_b32 v133, v198, v196, s73
  v_perm_b32 v137, v199, v197, s72
  v_perm_b32 v141, v199, v197, s73
  v_perm_b32 v130, v202, v200, s72
  v_perm_b32 v134, v202, v200, s73
  v_perm_b32 v138, v203, v201, s72
  v_perm_b32 v142, v203, v201, s73
  v_perm_b32 v131, v206, v204, s72
  v_perm_b32 v135, v206, v204, s73
  v_perm_b32 v139, v207, v205, s72
  v_perm_b32 v143, v207, v205, s73
  v_perm_b32 v144, v210, v208, s72
  v_perm_b32 v148, v210, v208, s73
  v_perm_b32 v152, v211, v209, s72
  v_perm_b32 v156, v211, v209, s73
  v_perm_b32 v145, v214, v212, s72
  v_perm_b32 v149, v214, v212, s73
  v_perm_b32 v153, v215, v213, s72
  v_perm_b32 v157, v215, v213, s73
  v_perm_b32 v146, v218, v216, s72
  v_perm_b32 v150, v218, v216, s73
  v_perm_b32 v154, v219, v217, s72
  v_perm_b32 v158, v219, v217, s73
  v_perm_b32 v147, v222, v220, s72
  v_perm_b32 v151, v222, v220, s73
  v_perm_b32 v155, v223, v221, s72
  v_perm_b32 v159, v223, v221, s73
  v_perm_b32 v160, v226, v224, s72
  v_perm_b32 v164, v226, v224, s73
  v_perm_b32 v168, v227, v225, s72
  v_perm_b32 v172, v227, v225, s73
  v_perm_b32 v161, v230, v228, s72
  v_perm_b32 v165, v230, v228, s73
  v_perm_b32 v169, v231, v229, s72
  v_perm_b32 v173, v231, v229, s73
  v_perm_b32 v162, v234, v232, s72
  v_perm_b32 v166, v234, v232, s73
  v_perm_b32 v170, v235, v233, s72
  v_perm_b32 v174, v235, v233, s73
  v_perm_b32 v163, v238, v236, s72
  v_perm_b32 v167, v238, v236, s73
  v_perm_b32 v171, v239, v237, s72
  v_perm_b32 v175, v239, v237, s73
  v_perm_b32 v176, v242, v240, s72
  v_perm_b32 v180, v242, v240, s73
  v_perm_b32 v184, v243, v241, s72
  v_perm_b32 v188, v243, v241, s73
  v_perm_b32 v177, v246, v244, s72
  v_perm_b32 v181, v246, v244, s73
  v_perm_b32 v185, v247, v245, s72
  v_perm_b32 v189, v247, v245, s73
  v_perm_b32 v178, v250, v248, s72
  v_perm_b32 v182, v250, v248, s73
  v_perm_b32 v186, v251, v249, s72
  v_perm_b32 v190, v251, v249, s73
  v_perm_b32 v179, v254, v252, s72
  v_perm_b32 v183, v254, v252, s73
  v_perm_b32 v187, v255, v253, s72
  v_perm_b32 v191, v255, v253, s73
  s_mov_b32 s52, s36
  s_mov_b32 s53, s37
  s_mov_b32 s54, 2048
  s_mov_b32 s55, 0x20000
  s_lshr_b32 s4, s3, 2
  s_lshl_b32 s4, s4, 5
  s_add_u32 s4, s4, s8
  s_mul_i32 s6, s4, 12288
  s_and_b32 s5, s3, 3
  s_mul_i32 s5, s5, 3072
  s_add_u32 s6, s6, s5
  s_add_u32 s6, s6, 1048576
  v_lshlrev_b32 v43, 4, v1
  s_mul_i32 s5, s3, 272
  v_lshlrev_b32 v44, 2, v1
  v_add_u32 v44, s5, v44
  v_and_b32 v45, 7, v1
  v_mul_u32_u24 v45, 272, v45
  v_lshl_add_u32 v45, v7, 6, v45
  s_lshl_b32 s5, s3, 3
  v_mov_b32 v46, s5
  v_and_b32 v47, 1, v7
  v_lshlrev_b32 v47, 5, v47
  s_lshl_b32 s7, s8, 12
  s_add_u32 s7, s7, 262144
  buffer_load_dwordx2 v[104:105], v17, s[44:47], s32 offen sc1
  buffer_load_dwordx2 v[108:109], v17, s[44:47], s33 offen sc1
  buffer_load_dwordx2 v[112:113], v54, s[44:47], s23 offen sc1
  s_mov_b32 s58, s42
  s_mov_b64 s[74:75], -1
Lppouter_52:
  buffer_load_dwordx4 v[24:27], v43, s[44:47], s6 offen offset:0 sc1
  buffer_load_dwordx4 v[28:31], v43, s[44:47], s6 offen offset:1024 sc1
  buffer_load_dwordx4 v[32:35], v43, s[44:47], s6 offen offset:2048 sc1
Lpp_50:
  s_waitcnt vmcnt(0)
  v_cmpx_eq_u32 vcc, v25, v8
  v_cmpx_eq_u32 vcc, v27, v8
  v_cmpx_eq_u32 vcc, v29, v8
  v_cmpx_eq_u32 vcc, v31, v8
  v_cmpx_eq_u32 vcc, v33, v8
  v_cmpx_eq_u32 vcc, v35, v8
  s_nop 0
  s_cbranch_execz Lppre_53
  s_andn2_b64 s[74:75], s[74:75], exec
  s_cbranch_scc0 Lppdone_51
Lppre_53:
  s_mov_b64 exec, s[74:75]
  v_cmpx_ne_u32 vcc, v25, v8
  v_cmpx_ne_u32 vcc, v29, v8
  v_cmpx_ne_u32 vcc, v33, v8
  s_nop 0
  s_cmp_eq_u64 exec, -1
  s_mov_b64 exec, s[74:75]
  s_cbranch_scc0 Lpplz_54
  s_sleep 8
Lpplz_54:
  buffer_load_dwordx4 v[24:27], v43, s[44:47], s6 offen offset:0 sc1
  buffer_load_dwordx4 v[28:31], v43, s[44:47], s6 offen offset:1024 sc1
  buffer_load_dwordx4 v[32:35], v43, s[44:47], s6 offen offset:2048 sc1
  s_sub_u32 s58, s58, 1
  s_cbranch_scc0 Lpp_50
Lppdone_51:
  s_mov_b64 exec, -1
  s_nop 1
  v_max3_f32 v40, v26, v30, v34
  v_lshlrev_b32 v25, 16, v24
  v_sub_f32 v26, v26, v40
  v_sub_f32 v30, v30, v40
  v_sub_f32 v34, v34, v40
  v_exp_f32 v26, v26
  v_exp_f32 v30, v30
  v_exp_f32 v34, v34
  v_and_b32 v24, 0xffff0000, v24
  v_lshlrev_b32 v29, 16, v28
  v_and_b32 v28, 0xffff0000, v28
  v_lshlrev_b32 v33, 16, v32
  v_and_b32 v32, 0xffff0000, v32
  v_mul_f32 v22, v25, v26
  v_mul_f32 v23, v24, v26
  v_add_f32 v41, v26, v30
  v_fmac_f32 v22, v29, v30
  v_fmac_f32 v23, v28, v30
  v_add_f32 v41, v41, v34
  v_fmac_f32 v22, v33, v34
  v_fmac_f32 v23, v32, v34
  ds_write_b64 v46, v[40:41] offset:4608
  v_cvt_pk_bf16_f32 v22, v22, v23
  ds_write_b32 v44, v22 offset:0
  s_waitcnt lgkmcnt(0)
  s_barrier
  ds_read_b128 v[64:67], v45 offset:0
  ds_read_b128 v[68:71], v45 offset:16
  ds_read_b128 v[72:75], v45 offset:32
  ds_read_b128 v[76:79], v45 offset:48
  ds_read_b128 v[24:27], v47 offset:4608
  ds_read_b128 v[28:31], v47 offset:4624
  s_waitcnt lgkmcnt(5)
  v_mfma_f32_16x16x32_bf16 v[80:83], v[64:67], v[128:131], 0
  v_mfma_f32_16x16x32_bf16 v[84:87], v[64:67], v[132:135], 0
  v_mfma_f32_16x16x32_bf16 v[88:91], v[64:67], v[136:139], 0
  v_mfma_f32_16x16x32_bf16 v[92:95], v[64:67], v[140:143], 0
  s_waitcnt lgkmcnt(0)
  v_max3_f32 v9, v24, v26, v28
  v_max_f32 v9, v9, v30
  v_mfma_f32_16x16x32_bf16 v[80:83], v[68:71], v[144:147], v[80:83]
  v_mfma_f32_16x16x32_bf16 v[84:87], v[68:71], v[148:151], v[84:87]
  v_mfma_f32_16x16x32_bf16 v[88:91], v[68:71], v[152:155], v[88:91]
  v_mfma_f32_16x16x32_bf16 v[92:95], v[68:71], v[156:159], v[92:95]
  v_sub_f32 v24, v24, v9
  v_sub_f32 v26, v26, v9
  v_sub_f32 v28, v28, v9
  v_sub_f32 v30, v30, v9
  v_exp_f32 v24, v24
  v_exp_f32 v26, v26
  v_exp_f32 v28, v28
  v_exp_f32 v30, v30
  v_mfma_f32_16x16x32_bf16 v[80:83], v[72:75], v[160:163], v[80:83]
  v_mfma_f32_16x16x32_bf16 v[84:87], v[72:75], v[164:167], v[84:87]
  v_mfma_f32_16x16x32_bf16 v[88:91], v[72:75], v[168:171], v[88:91]
  v_mfma_f32_16x16x32_bf16 v[92:95], v[72:75], v[172:175], v[92:95]
  v_mul_f32 v9, v24, v25
  v_fmac_f32 v9, v26, v27
  v_fmac_f32 v9, v28, v29
  v_fmac_f32 v9, v30, v31
  v_rcp_f32 v9, v9
  v_mfma_f32_16x16x32_bf16 v[80:83], v[76:79], v[176:179], v[80:83]
  v_mfma_f32_16x16x32_bf16 v[84:87], v[76:79], v[180:183], v[84:87]
  v_mfma_f32_16x16x32_bf16 v[88:91], v[76:79], v[184:187], v[88:91]
  v_mfma_f32_16x16x32_bf16 v[92:95], v[76:79], v[188:191], v[92:95]
  v_mul_f32 v24, v24, v9
  v_mul_f32 v26, v26, v9
  v_mul_f32 v28, v28, v9
  v_mul_f32 v30, v30, v9
  s_nop 0
  v_mul_f32 v80, v80, v24
  v_mul_f32 v84, v84, v24
  v_mul_f32 v88, v88, v24
  v_mul_f32 v92, v92, v24
  v_fmac_f32 v80, v81, v26
  v_fmac_f32 v84, v85, v26
  v_fmac_f32 v88, v89, v26
  v_fmac_f32 v92, v93, v26
  v_fmac_f32 v80, v82, v28
  v_fmac_f32 v84, v86, v28
  v_fmac_f32 v88, v90, v28
  v_fmac_f32 v92, v94, v28
  v_fmac_f32 v80, v83, v30
  v_fmac_f32 v84, v87, v30
  v_fmac_f32 v88, v91, v30
  v_fmac_f32 v92, v95, v30
  v_cvt_pk_bf16_f32 v56, v80, v84
  v_cvt_pk_bf16_f32 v58, v88, v92
  s_mov_b32 exec_hi, 0
  buffer_store_dwordx4 v[56:59], v18, s[44:47], s7 offen offset:0 sc1
  s_mov_b32 exec_hi, -1
  s_cmp_ge_u32 s3, 4
  s_cbranch_scc1 L_rdone
  v_mov_b32 v22, 0
  v_mov_b32 v23, 0
  s_mov_b32 s58, s42
  s_mov_b64 s[74:75], -1
Lpoll_55:
  buffer_load_dwordx2 v[24:25], v54, s[44:47], s23 offen sc1
  s_waitcnt vmcnt(0)
  v_cmpx_eq_u32 vcc, v25, v8
  s_nop 0
  s_andn2_b64 s[74:75], s[74:75], exec
  s_cbranch_scc0 Lpdone_56
  s_mov_b64 exec, s[74:75]
  s_sleep 2
  s_sub_u32 s58, s58, 1
  s_cbranch_scc0 Lpoll_55
Lpdone_56:
  s_mov_b64 exec, -1
  s_nop 1
  v_lshlrev_b32 v26, 16, v24
  v_and_b32 v27, 0xffff0000, v24
  s_mov_b32 s58, s42
  s_mov_b32 s74, -1
  s_mov_b32 s75, 0x00ffffff
  s_mov_b64 exec, s[74:75]
Lppouter_59:
  buffer_load_dwordx2 v[96:97], v17, s[44:47], s32 offen sc1
  buffer_load_dwordx2 v[98:99], v17, s[44:47], s33 offen sc1
  s_sleep 2
  buffer_load_dwordx2 v[100:101], v17, s[44:47], s32 offen sc1
  buffer_load_dwordx2 v[102:103], v17, s[44:47], s33 offen sc1
  s_sleep 2
  buffer_load_dwordx2 v[104:105], v17, s[44:47], s32 offen sc1
  buffer_load_dwordx2 v[106:107], v17, s[44:47], s33 offen sc1
Lpp_57:
  s_waitcnt vmcnt(4)
  v_cmpx_eq_u32 vcc, v97, v8
  v_cmpx_eq_u32 vcc, v99, v8
  s_nop 0
  s_cbranch_execz Lppre_60
  v_dot2_f32_bf16 v22, v96, s70, 0
  v_dot2_f32_bf16 v23, v96, s71, 0
  v_dot2_f32_bf16 v22, v98, s70, v22
  v_dot2_f32_bf16 v23, v98, s71, v23
  s_andn2_b64 s[74:75], s[74:75], exec
  s_cbranch_scc0 Lppdone_58
Lppre_60:
  s_mov_b64 exec, s[74:75]
  buffer_load_dwordx2 v[96:97], v17, s[44:47], s32 offen sc1
  buffer_load_dwordx2 v[98:99], v17, s[44:47], s33 offen sc1
  s_waitcnt vmcnt(4)
  v_cmpx_eq_u32 vcc, v101, v8
  v_cmpx_eq_u32 vcc, v103, v8
  s_nop 0
  s_cbranch_execz Lppre_61
  v_dot2_f32_bf16 v22, v100, s70, 0
  v_dot2_f32_bf16 v23, v100, s71, 0
  v_dot2_f32_bf16 v22, v102, s70, v22
  v_dot2_f32_bf16 v23, v102, s71, v23
  s_andn2_b64 s[74:75], s[74:75], exec
  s_cbranch_scc0 Lppdone_58
Lppre_61:
  s_mov_b64 exec, s[74:75]
  buffer_load_dwordx2 v[100:101], v17, s[44:47], s32 offen sc1
  buffer_load_dwordx2 v[102:103], v17, s[44:47], s33 offen sc1
  s_waitcnt vmcnt(4)
  v_cmpx_eq_u32 vcc, v105, v8
  v_cmpx_eq_u32 vcc, v107, v8
  s_nop 0
  s_cbranch_execz Lppre_62
  v_dot2_f32_bf16 v22, v104, s70, 0
  v_dot2_f32_bf16 v23, v104, s71, 0
  v_dot2_f32_bf16 v22, v106, s70, v22
  v_dot2_f32_bf16 v23, v106, s71, v23
  s_andn2_b64 s[74:75], s[74:75], exec
  s_cbranch_scc0 Lppdone_58
Lppre_62:
  s_mov_b64 exec, s[74:75]
  buffer_load_dwordx2 v[104:105], v17, s[44:47], s32 offen sc1
  buffer_load_dwordx2 v[106:107], v17, s[44:47], s33 offen sc1
  s_sub_u32 s58, s58, 1
  s_cbranch_scc0 Lpp_57
Lppdone_58:
  s_mov_b64 exec, -1
  s_nop 1
  v_add_f32_dpp v22, v22, v22 row_ror:4 row_mask:0xf bank_mask:0xf
  v_add_f32_dpp v23, v23, v23 row_ror:4 row_mask:0xf bank_mask:0xf
  s_nop 0
  v_add_f32_dpp v22, v22, v22 row_ror:8 row_mask:0xf bank_mask:0xf
  v_add_f32_dpp v23, v23, v23 row_ror:8 row_mask:0xf bank_mask:0xf
  v_mov_b32 v9, v22
  v_mov_b32 v10, v23
  s_nop 0
  v_permlane16_swap_b32 v22, v9
  v_permlane16_swap_b32 v23, v10
  v_add_f32 v22, v22, v9
  v_add_f32 v23, v23, v10
  v_mov_b32 v9, v22
  v_mov_b32 v10, v23
  s_nop 0
  v_permlane32_swap_b32 v22, v9
  v_permlane32_swap_b32 v23, v10
  v_add_f32 v22, v22, v9
  v_add_f32 v23, v23, v10
  v_cvt_pk_bf16_f32 v11, v22, v23
  v_lshlrev_b32 v22, 16, v11
  v_and_b32 v23, 0xffff0000, v11
  v_mul_f32 v22, v22, v36
  v_mul_f32 v23, v23, v37
  v_cvt_pk_bf16_f32 v11, v22, v23
  v_lshlrev_b32 v22, 16, v11
  v_and_b32 v23, 0xffff0000, v11
  v_add_f32 v22, v22, v26
  v_add_f32 v23, v23, v27
  v_cvt_pk_bf16_f32 v22, v22, v23
  s_mov_b64 exec, 0xf
  buffer_store_dword v22, v55, s[52:55], s56 offen
  s_cmp_lg_u32 s10, 0
  s_cbranch_scc1 Lnotag0_63
  v_mov_b32 v9, 0
  s_mov_b64 exec, 1
  buffer_store_dword v9, v9, s[48:51], 0 offen
Lnotag0_63:
  s_mov_b64 exec, -1
  s_branch L_rdone
L_ffn:
  s_nop 1
  s_getreg_b32 s67, hwreg(HW_REG_XCC_ID)
  s_and_b32 s67, s67, 15
  s_cmp_ge_u32 s8, 28
  s_cbranch_scc1 Lnoffw_64
  s_mov_b32 s52, s28
  s_mov_b32 s53, s29
  s_mov_b32 s54, 1835008
  s_mov_b32 s55, 0x20000
  s_mul_i32 s4, s3, 229376
  s_lshl_b32 s5, s8, 7
  s_add_u32 s4, s4, s5
  v_mul_u32_u24 v9, 57344, v7
  v_add_u32 v9, v9, v6
  buffer_load_dwordx2 v[192:193], v9, s[52:55], s4 offen nt
  s_add_u32 s4, s4, 3584
  buffer_load_dwordx2 v[194:195], v9, s[52:55], s4 offen nt
  s_add_u32 s4, s4, 3584
  buffer_load_dwordx2 v[196:197], v9, s[52:55], s4 offen nt
  s_add_u32 s4, s4, 3584
  buffer_load_dwordx2 v[198:199], v9, s[52:55], s4 offen nt
  s_add_u32 s4, s4, 3584
  buffer_load_dwordx2 v[200:201], v9, s[52:55], s4 offen nt
  s_add_u32 s4, s4, 3584
  buffer_load_dwordx2 v[202:203], v9, s[52:55], s4 offen nt
  s_add_u32 s4, s4, 3584
  buffer_load_dwordx2 v[204:205], v9, s[52:55], s4 offen nt
  s_add_u32 s4, s4, 3584
  buffer_load_dwordx2 v[206:207], v9, s[52:55], s4 offen nt
  s_add_u32 s4, s4, 3584
  buffer_load_dwordx2 v[208:209], v9, s[52:55], s4 offen nt
  s_add_u32 s4, s4, 3584
  buffer_load_dwordx2 v[210:211], v9, s[52:55], s4 offen nt
  s_add_u32 s4, s4, 3584
  buffer_load_dwordx2 v[212:213], v9, s[52:55], s4 offen nt
  s_add_u32 s4, s4, 3584
  buffer_load_dwordx2 v[214:215], v9, s[52:55], s4 offen nt
  s_add_u32 s4, s4, 3584
  buffer_load_dwordx2 v[216:217], v9, s[52:55], s4 offen nt
  s_add_u32 s4, s4, 3584
  buffer_load_dwordx2 v[218:219], v9, s[52:55], s4 offen nt
  s_add_u32 s4, s4, 3584
  buffer_load_dwordx2 v[220:221], v9, s[52:55], s4 offen nt
  s_add_u32 s4, s4, 3584
  buffer_load_dwordx2 v[222:223], v9, s[52:55], s4 offen nt
  s_cmp_ge_u32 s3, 4
  s_cbranch_scc1 Lnoffw_64
  s_mov_b32 s52, s30
  s_mov_b32 s53, s31
  s_mov_b32 s54, 1835008
  s_mov_b32 s55, 0x20000
  s_lshl_b32 s4, s8, 16
  s_lshl_b32 s5, s3, 8
  s_add_u32 s4, s4, s5
  v_mul_u32_u24 v9, 16384, v7
  v_add_u32 v9, v9, v6
  buffer_load_dwordx2 v[224:225], v9, s[52:55], s4 offen nt
  s_add_u32 s4, s4, 1024
  buffer_load_dwordx2 v[226:227], v9, s[52:55], s4 offen nt
  s_add_u32 s4, s4, 1024
  buffer_load_dwordx2 v[228:229], v9, s[52:55], s4 offen nt
  s_add_u32 s4, s4, 1024
  buffer_load_dwordx2 v[230:231], v9, s[52:55], s4 offen nt
  s_add_u32 s4, s4, 1024
  buffer_load_dwordx2 v[232:233], v9, s[52:55], s4 offen nt
  s_add_u32 s4, s4, 1024
  buffer_load_dwordx2 v[234:235], v9, s[52:55], s4 offen nt
  s_add_u32 s4, s4, 1024
  buffer_load_dwordx2 v[236:237], v9, s[52:55], s4 offen nt
  s_add_u32 s4, s4, 1024
  buffer_load_dwordx2 v[238:239], v9, s[52:55], s4 offen nt
  s_add_u32 s4, s4, 1024
  buffer_load_dwordx2 v[240:241], v9, s[52:55], s4 offen nt
  s_add_u32 s4, s4, 1024
  buffer_load_dwordx2 v[242:243], v9, s[52:55], s4 offen nt
  s_add_u32 s4, s4, 1024
  buffer_load_dwordx2 v[244:245], v9, s[52:55], s4 offen nt
  s_add_u32 s4, s4, 1024
  buffer_load_dwordx2 v[246:247], v9, s[52:55], s4 offen nt
  s_add_u32 s4, s4, 1024
  buffer_load_dwordx2 v[248:249], v9, s[52:55], s4 offen nt
  s_add_u32 s4, s4, 1024
  buffer_load_dwordx2 v[250:251], v9, s[52:55], s4 offen nt
  s_add_u32 s4, s4, 1024
  buffer_load_dwordx2 v[252:253], v9, s[52:55], s4 offen nt
  s_add_u32 s4, s4, 1024
  buffer_load_dwordx2 v[254:255], v9, s[52:55], s4 offen nt
  s_mov_b32 s52, s30
  s_mov_b32 s53, s31
  s_mov_b32 s54, 1835008
  s_mov_b32 s55, 0x20000
  s_lshl_b32 s4, s8, 16
  s_lshl_b32 s5, s3, 8
  s_add_u32 s4, s4, s5
  s_add_u32 s4, s4, 128
  v_mul_u32_u24 v9, 16384, v7
  v_add_u32 v9, v9, v6
  buffer_load_dwordx2 v[96:97], v9, s[52:55], s4 offen nt
  s_add_u32 s4, s4, 1024
  buffer_load_dwordx2 v[98:99], v9, s[52:55], s4 offen nt
  s_add_u32 s4, s4, 1024
  buffer_load_dwordx2 v[100:101], v9, s[52:55], s4 offen nt
  s_add_u32 s4, s4, 1024
  buffer_load_dwordx2 v[102:103], v9, s[52:55], s4 offen nt
  s_add_u32 s4, s4, 1024
  buffer_load_dwordx2 v[104:105], v9, s[52:55], s4 offen nt
  s_add_u32 s4, s4, 1024
  buffer_load_dwordx2 v[106:107], v9, s[52:55], s4 offen nt
  s_add_u32 s4, s4, 1024
  buffer_load_dwordx2 v[108:109], v9, s[52:55], s4 offen nt
  s_add_u32 s4, s4, 1024
  buffer_load_dwordx2 v[110:111], v9, s[52:55], s4 offen nt
  s_add_u32 s4, s4, 1024
  buffer_load_dwordx2 v[112:113], v9, s[52:55], s4 offen nt
  s_add_u32 s4, s4, 1024
  buffer_load_dwordx2 v[114:115], v9, s[52:55], s4 offen nt
  s_add_u32 s4, s4, 1024
  buffer_load_dwordx2 v[116:117], v9, s[52:55], s4 offen nt
  s_add_u32 s4, s4, 1024
  buffer_load_dwordx2 v[118:119], v9, s[52:55], s4 offen nt
  s_add_u32 s4, s4, 1024
  buffer_load_dwordx2 v[120:121], v9, s[52:55], s4 offen nt
  s_add_u32 s4, s4, 1024
  buffer_load_dwordx2 v[122:123], v9, s[52:55], s4 offen nt
  s_add_u32 s4, s4, 1024
  buffer_load_dwordx2 v[124:125], v9, s[52:55], s4 offen nt
  s_add_u32 s4, s4, 1024
  buffer_load_dwordx2 v[126:127], v9, s[52:55], s4 offen nt
Lnoffw_64:
  s_lshr_b32 s43, s2, 3
  s_sub_u32 s4, s43, s3
  s_lshl_b32 s5, s4, 7
  v_add_u32 v55, s5, v12
  s_lshl_b32 s5, s4, 8
  v_add_u32 v54, s5, v19
  buffer_load_dword v3, v55, s[12:15], 0 offen
  s_lshl_b32 s4, s43, 9
  s_add_u32 s22, s26, s4
  s_lshl_b32 s5, s3, 14
  s_add_u32 s4, s4, s5
  s_add_u32 s18, s4, 262144
  s_add_u32 s19, s18, 4096
  s_add_u32 s20, s18, 8192
  s_add_u32 s21, s18, 12288
  s_mov_b32 s57, 4096
  s_mov_b32 s5, 6144
  v_and_b32 v9, 7, v1
  v_lshlrev_b32 v9, 10, v9
  s_and_b32 s4, s2, 7
  s_lshl_b32 s4, s4, 7
  s_add_u32 s4, s4, 114688
  s_mov_b32 s58, s42
  s_mov_b64 s[74:75], -1
Lpoll_65:
  buffer_load_dwordx2 v[20:21], v54, s[44:47], s57 offen sc1
  buffer_load_dwordx2 v[40:41], v19, s[44:47], s5 offen sc1
  buffer_load_dwordx2 v[42:43], v19, s[44:47], s5 offen offset:2048 sc1
  buffer_load_dwordx2 v[22:23], v9, s[44:47], s4 offen sc1
  s_waitcnt vmcnt(0)
  v_cmpx_eq_u32 vcc, v21, v8
  v_cmpx_eq_u32 vcc, v41, v8
  v_cmpx_eq_u32 vcc, v43, v8
  v_cmpx_eq_u32 vcc, v23, v8
  s_nop 0
  s_andn2_b64 s[74:75], s[74:75], exec
  s_cbranch_scc0 Lpdone_66
  s_mov_b64 exec, s[74:75]
  s_sleep 4
  s_sub_u32 s58, s58, 1
  s_cbranch_scc0 Lpoll_65
Lpdone_66:
  s_mov_b64 exec, -1
  s_nop 1
  v_cmp_ne_u32 s[66:67], s67, v22
  v_lshlrev_b32 v4, 16, v20
  v_and_b32 v5, 0xffff0000, v20
  v_lshlrev_b32 v2, 16, v3
  v_and_b32 v3, 0xffff0000, v3
  v_perm_b32 v128, v194, v192, s72
  v_perm_b32 v132, v194, v192, s73
  v_perm_b32 v136, v195, v193, s72
  v_perm_b32 v140, v195, v193, s73
  v_perm_b32 v129, v198, v196, s72
  v_perm_b32 v133, v198, v196, s73
  v_perm_b32 v137, v199, v197, s72
  v_perm_b32 v141, v199, v197, s73
  v_perm_b32 v130, v202, v200, s72
  v_perm_b32 v134, v202, v200, s73
  v_perm_b32 v138, v203, v201, s72
  v_perm_b32 v142, v203, v201, s73
  v_perm_b32 v131, v206, v204, s72
  v_perm_b32 v135, v206, v204, s73
  v_perm_b32 v139, v207, v205, s72
  v_perm_b32 v143, v207, v205, s73
  v_perm_b32 v144, v210, v208, s72
  v_perm_b32 v148, v210, v208, s73
  v_perm_b32 v152, v211, v209, s72
  v_perm_b32 v156, v211, v209, s73
  v_perm_b32 v145, v214, v212, s72
  v_perm_b32 v149, v214, v212, s73
  v_perm_b32 v153, v215, v213, s72
  v_perm_b32 v157, v215, v213, s73
  v_perm_b32 v146, v218, v216, s72
  v_perm_b32 v150, v218, v216, s73
  v_perm_b32 v154, v219, v217, s72
  v_perm_b32 v158, v219, v217, s73
  v_perm_b32 v147, v222, v220, s72
  v_perm_b32 v151, v222, v220, s73
  v_perm_b32 v155, v223, v221, s72
  v_perm_b32 v159, v223, v221, s73
  v_perm_b32 v160, v226, v224, s72
  v_perm_b32 v164, v226, v224, s73
  v_perm_b32 v168, v227, v225, s72
  v_perm_b32 v172, v227, v225, s73
  v_perm_b32 v161, v230, v228, s72
  v_perm_b32 v165, v230, v228, s73
  v_perm_b32 v169, v231, v229, s72
  v_perm_b32 v173, v231, v229, s73
  v_perm_b32 v162, v234, v232, s72
  v_perm_b32 v166, v234, v232, s73
  v_perm_b32 v170, v235, v233, s72
  v_perm_b32 v174, v235, v233, s73
  v_perm_b32 v163, v238, v236, s72
  v_perm_b32 v167, v238, v236, s73
  v_perm_b32 v171, v239, v237, s72
  v_perm_b32 v175, v239, v237, s73
  v_perm_b32 v176, v242, v240, s72
  v_perm_b32 v180, v242, v240, s73
  v_perm_b32 v184, v243, v241, s72
  v_perm_b32 v188, v243, v241, s73
  v_perm_b32 v177, v246, v244, s72
  v_perm_b32 v181, v246, v244, s73
  v_perm_b32 v185, v247, v245, s72
  v_perm_b32 v189, v247, v245, s73
  v_perm_b32 v178, v250, v248, s72
  v_perm_b32 v182, v250, v248, s73
  v_perm_b32 v186, v251, v249, s72
  v_perm_b32 v190, v251, v249, s73
  v_perm_b32 v179, v254, v252, s72
  v_perm_b32 v183, v254, v252, s73
  v_perm_b32 v187, v255, v253, s72
  v_perm_b32 v191, v255, v253, s73
  v_perm_b32 v192, v98, v96, s72
  v_perm_b32 v196, v98, v96, s73
  v_perm_b32 v200, v99, v97, s72
  v_perm_b32 v204, v99, v97, s73
  v_perm_b32 v193, v102, v100, s72
  v_perm_b32 v197, v102, v100, s73
  v_perm_b32 v201, v103, v101, s72
  v_perm_b32 v205, v103, v101, s73
  v_perm_b32 v194, v106, v104, s72
  v_perm_b32 v198, v106, v104, s73
  v_perm_b32 v202, v107, v105, s72
  v_perm_b32 v206, v107, v105, s73
  v_perm_b32 v195, v110, v108, s72
  v_perm_b32 v199, v110, v108, s73
  v_perm_b32 v203, v111, v109, s72
  v_perm_b32 v207, v111, v109, s73
  v_perm_b32 v208, v114, v112, s72
  v_perm_b32 v212, v114, v112, s73
  v_perm_b32 v216, v115, v113, s72
  v_perm_b32 v220, v115, v113, s73
  v_perm_b32 v209, v118, v116, s72
  v_perm_b32 v213, v118, v116, s73
  v_perm_b32 v217, v119, v117, s72
  v_perm_b32 v221, v119, v117, s73
  v_perm_b32 v210, v122, v120, s72
  v_perm_b32 v214, v122, v120, s73
  v_perm_b32 v218, v123, v121, s72
  v_perm_b32 v222, v123, v121, s73
  v_perm_b32 v211, v126, v124, s72
  v_perm_b32 v215, v126, v124, s73
  v_perm_b32 v219, v127, v125, s72
  v_perm_b32 v223, v127, v125, s73
  v_lshlrev_b32 v48, 16, v42
  v_and_b32 v49, 0xffff0000, v42
  v_add_f32 v48, 1.0, v48
  v_add_f32 v49, 1.0, v49
  v_cvt_pk_bf16_f32 v42, v48, v49
  v_lshlrev_b32 v48, 16, v42
  v_and_b32 v49, 0xffff0000, v42
  ds_write_b32 v14, v42 offset:0
  ds_write_b32 v14, v40 offset:256
  v_bfe_u32 v9, v1, 3, 1
  v_lshl_add_u32 v9, v9, 8, v15
  ds_read_b128 v[64:67], v9 offset:0
  ds_read_b128 v[68:71], v9 offset:16
  s_waitcnt lgkmcnt(0)
  v_mfma_f32_16x16x32_bf16 v[80:83], v[64:67], v[128:131], 0
  v_mfma_f32_16x16x32_bf16 v[84:87], v[64:67], v[132:135], 0
  v_mfma_f32_16x16x32_bf16 v[88:91], v[64:67], v[136:139], 0
  v_mfma_f32_16x16x32_bf16 v[92:95], v[64:67], v[140:143], 0
  v_mfma_f32_16x16x32_bf16 v[80:83], v[68:71], v[144:147], v[80:83]
  v_mfma_f32_16x16x32_bf16 v[84:87], v[68:71], v[148:151], v[84:87]
  v_mfma_f32_16x16x32_bf16 v[88:91], v[68:71], v[152:155], v[88:91]
  v_mfma_f32_16x16x32_bf16 v[92:95], v[68:71], v[156:159], v[92:95]
  v_add_u32 v20, 24576, v16
  s_nop 4
  ds_write2_b32 v20, v80, v84 offset0:0 offset1:1
  s_nop 0
  ds_write2_b32 v20, v88, v92 offset0:2 offset1:3
  s_waitcnt lgkmcnt(0)
  s_barrier
  ds_read_b64 v[96:97], v13 offset:24576
  ds_read_b64 v[98:99], v13 offset:25600
  ds_read_b64 v[100:101], v13 offset:26624
  ds_read_b64 v[102:103], v13 offset:27648
  ds_read_b64 v[104:105], v13 offset:28672
  ds_read_b64 v[106:107], v13 offset:29696
  ds_read_b64 v[108:109], v13 offset:30720
  ds_read_b64 v[110:111], v13 offset:31744
  s_waitcnt lgkmcnt(0)
  v_pk_add_f32 v[96:97], v[96:97], v[98:99]
  v_pk_add_f32 v[100:101], v[100:101], v[102:103]
  v_pk_add_f32 v[104:105], v[104:105], v[106:107]
  v_pk_add_f32 v[108:109], v[108:109], v[110:111]
  v_pk_add_f32 v[96:97], v[96:97], v[100:101]
  v_pk_add_f32 v[104:105], v[104:105], v[108:109]
  v_pk_add_f32 v[50:51], v[96:97], v[104:105]
  ds_read_b64 v[96:97], v13 offset:25088
  ds_read_b64 v[98:99], v13 offset:26112
  ds_read_b64 v[100:101], v13 offset:27136
  ds_read_b64 v[102:103], v13 offset:28160
  ds_read_b64 v[104:105], v13 offset:29184
  ds_read_b64 v[106:107], v13 offset:30208
  ds_read_b64 v[108:109], v13 offset:31232
  ds_read_b64 v[110:111], v13 offset:32256
  s_waitcnt lgkmcnt(0)
  v_pk_add_f32 v[96:97], v[96:97], v[98:99]
  v_pk_add_f32 v[100:101], v[100:101], v[102:103]
  v_pk_add_f32 v[104:105], v[104:105], v[106:107]
  v_pk_add_f32 v[108:109], v[108:109], v[110:111]
  v_pk_add_f32 v[96:97], v[96:97], v[100:101]
  v_pk_add_f32 v[104:105], v[104:105], v[108:109]
  v_pk_add_f32 v[52:53], v[96:97], v[104:105]
  v_lshrrev_b32 v9, 5, v1
  s_lshl_b32 s4, s3, 9
  v_add_u32 v44, s4, v13
  v_lshlrev_b32 v45, 6, v9
  s_lshl_b32 s4, s3, 3
  v_add_u32 v47, s4, v45
  s_lshl_b32 s7, s8, 12
  s_add_u32 s7, s7, 524288
  v_add_u32 v20, 8192, v16
  s_lshl_b32 s4, s3, 10
  v_add_u32 v17, s4, v13
  v_mov_b32 v61, v8
  v_mov_b32 v63, v8
  s_add_u32 s9, s26, 0x4000
  s_mov_b32 s58, s42
  s_mov_b64 s[74:75], -1
Lppouter_69:
  buffer_load_dwordx2 v[224:225], v13, s[44:47], s18 offen sc1
  buffer_load_dwordx2 v[226:227], v13, s[44:47], s19 offen sc1
  buffer_load_dwordx2 v[228:229], v13, s[44:47], s20 offen sc1
  buffer_load_dwordx2 v[230:231], v13, s[44:47], s21 offen sc1
Lpp_67:
  s_waitcnt vmcnt(0)
  v_cmpx_eq_u32 vcc, v225, v8
  v_cmpx_eq_u32 vcc, v227, v8
  v_cmpx_eq_u32 vcc, v229, v8
  v_cmpx_eq_u32 vcc, v231, v8
  s_nop 0
  s_cbranch_execz Lppre_70
  v_dot2_f32_bf16 v22, v224, s70, 0
  v_dot2_f32_bf16 v23, v224, s71, 0
  v_dot2_f32_bf16 v22, v226, s70, v22
  v_dot2_f32_bf16 v23, v226, s71, v23
  v_dot2_f32_bf16 v22, v228, s70, v22
  v_dot2_f32_bf16 v23, v228, s71, v23
  v_dot2_f32_bf16 v22, v230, s70, v22
  v_dot2_f32_bf16 v23, v230, s71, v23
  s_andn2_b64 s[74:75], s[74:75], exec
  s_cbranch_scc0 Lppdone_68
Lppre_70:
  s_mov_b64 exec, s[74:75]
  v_cmpx_ne_u32 vcc, v225, v8
  v_cmpx_ne_u32 vcc, v227, v8
  v_cmpx_ne_u32 vcc, v229, v8
  v_cmpx_ne_u32 vcc, v231, v8
  s_nop 0
  s_cmp_eq_u64 exec, -1
  s_mov_b64 exec, s[74:75]
  s_cbranch_scc0 Lpplz_71
  s_sleep 3
  buffer_load_dwordx2 v[30:31], v44, s[44:47], s26 offen sc1
Lpplz_71:
  buffer_load_dwordx2 v[224:225], v13, s[44:47], s18 offen sc1
  buffer_load_dwordx2 v[226:227], v13, s[44:47], s19 offen sc1
  buffer_load_dwordx2 v[228:229], v13, s[44:47], s20 offen sc1
  buffer_load_dwordx2 v[230:231], v13, s[44:47], s21 offen sc1
  s_sub_u32 s58, s58, 1
  s_cbranch_scc0 Lpp_67
Lppdone_68:
  s_mov_b64 exec, -1
  s_nop 1
  ds_write_b64 v17, v[22:23] offset:16384
  s_cmp_lg_u32 s3, 0
  s_waitcnt lgkmcnt(0)
  s_barrier
  s_cbranch_scc1 Lx1done_73
  ds_read_b64 v[96:97], v13 offset:16384
  ds_read_b64 v[98:99], v13 offset:17408
  ds_read_b64 v[100:101], v13 offset:18432
  ds_read_b64 v[102:103], v13 offset:19456
  ds_read_b64 v[104:105], v13 offset:20480
  ds_read_b64 v[106:107], v13 offset:21504
  ds_read_b64 v[108:109], v13 offset:22528
  ds_read_b64 v[110:111], v13 offset:23552
  s_cmp_eq_u64 s[66:67], 0
  s_waitcnt lgkmcnt(0)
  v_pk_add_f32 v[96:97], v[96:97], v[98:99]
  v_pk_add_f32 v[100:101], v[100:101], v[102:103]
  v_pk_add_f32 v[104:105], v[104:105], v[106:107]
  v_pk_add_f32 v[108:109], v[108:109], v[110:111]
  v_pk_add_f32 v[96:97], v[96:97], v[100:101]
  v_pk_add_f32 v[104:105], v[104:105], v[108:109]
  v_pk_add_f32 v[22:23], v[96:97], v[104:105]
  v_cvt_pk_bf16_f32 v11, v22, v23
  v_lshlrev_b32 v22, 16, v11
  v_and_b32 v23, 0xffff0000, v11
  v_mul_f32 v22, v22, v4
  v_mul_f32 v23, v23, v5
  v_cvt_pk_bf16_f32 v11, v22, v23
  v_lshlrev_b32 v22, 16, v11
  v_and_b32 v23, 0xffff0000, v11
  v_add_f32 v22, v22, v2
  v_add_f32 v23, v23, v3
  v_cvt_pk_bf16_f32 v38, v22, v23
  s_cbranch_scc0 Lx1safe_72
  buffer_store_dwordx2 v[38:39], v13, s[44:47], s22 offen
  s_branch Lx1done_73
Lx1safe_72:
  buffer_store_dwordx2 v[38:39], v13, s[44:47], s22 offen sc1
Lx1done_73:
  s_mov_b32 s58, s42
  s_mov_b64 s[74:75], -1
Lppouter_76:
  buffer_load_dwordx2 v[30:31], v44, s[44:47], s26 offen sc1
Lpp_74:
  s_waitcnt vmcnt(0)
  v_cmpx_eq_u32 vcc, v31, v8
  s_nop 0
  s_cbranch_execz Lppre_77
  v_mov_b32 v24, v30
  s_andn2_b64 s[74:75], s[74:75], exec
  s_cbranch_scc0 Lppdone_75
Lppre_77:
  s_mov_b64 exec, s[74:75]
  buffer_load_dwordx2 v[30:31], v44, s[44:47], s26 offen sc1
  s_sub_u32 s58, s58, 1
  s_cbranch_scc0 Lpp_74
Lppdone_75:
  s_mov_b64 exec, -1
  s_nop 1
  s_cmp_lt_u32 s8, 28
  s_cbranch_scc1 Lisffn_78
  v_mov_b32 v25, v8
  s_barrier
  buffer_store_dwordx2 v[24:25], v44, s[44:47], s9 offen sc1
  s_branch L_rdone
Lisffn_78:
  v_lshlrev_b32 v22, 16, v24
  v_and_b32 v23, 0xffff0000, v24
  v_mul_f32 v9, v22, v48
  v_mul_f32 v10, v23, v49
  v_cvt_pk_bf16_f32 v9, v9, v10
  ds_write_b32 v14, v9 offset:0
  ds_read_b128 v[64:67], v15 offset:0
  ds_read_b128 v[68:71], v15 offset:16
  v_add_f32 v28, v22, v23
  v_mul_f32 v29, v22, v22
  v_fmac_f32 v29, v23, v23
  v_add_f32_dpp v28, v28, v28 quad_perm:[1,0,3,2] row_mask:0xf bank_mask:0xf
  s_nop 0
  v_add_f32_dpp v29, v29, v29 quad_perm:[1,0,3,2] row_mask:0xf bank_mask:0xf
  v_add_f32_dpp v28, v28, v28 quad_perm:[2,3,0,1] row_mask:0xf bank_mask:0xf
  s_nop 0
  v_add_f32_dpp v29, v29, v29 quad_perm:[2,3,0,1] row_mask:0xf bank_mask:0xf
  v_add_f32_dpp v28, v28, v28 row_half_mirror row_mask:0xf bank_mask:0xf
  s_nop 0
  v_add_f32_dpp v29, v29, v29 row_half_mirror row_mask:0xf bank_mask:0xf
  v_add_f32_dpp v28, v28, v28 row_mirror row_mask:0xf bank_mask:0xf
  s_nop 0
  v_add_f32_dpp v29, v29, v29 row_mirror row_mask:0xf bank_mask:0xf
  s_waitcnt lgkmcnt(0)
  v_mfma_f32_16x16x32_bf16 v[80:83], v[64:67], v[128:131], 0
  v_mfma_f32_16x16x32_bf16 v[84:87], v[64:67], v[132:135], 0
  v_mfma_f32_16x16x32_bf16 v[88:91], v[64:67], v[136:139], 0
  v_mfma_f32_16x16x32_bf16 v[92:95], v[64:67], v[140:143], 0
  v_mov_b32 v9, v28
  v_mov_b32 v10, v29
  s_nop 0
  v_permlane16_swap_b32 v28, v9
  v_permlane16_swap_b32 v29, v10
  v_add_f32 v28, v28, v9
  v_add_f32 v29, v29, v10
  v_mfma_f32_16x16x32_bf16 v[80:83], v[68:71], v[144:147], v[80:83]
  v_mfma_f32_16x16x32_bf16 v[84:87], v[68:71], v[148:151], v[84:87]
  v_mfma_f32_16x16x32_bf16 v[88:91], v[68:71], v[152:155], v[88:91]
  v_mfma_f32_16x16x32_bf16 v[92:95], v[68:71], v[156:159], v[92:95]
  ds_write_b64 v47, v[28:29] offset:4608
  s_nop 4
  ds_write2_b32 v20, v80, v84 offset0:0 offset1:1
  s_nop 0
  ds_write2_b32 v20, v88, v92 offset0:2 offset1:3
  s_cmp_ge_u32 s3, 4
  s_waitcnt lgkmcnt(0)
  s_barrier
  s_cbranch_scc1 L_rdone
  ds_read_b128 v[112:115], v45 offset:4608
  ds_read_b128 v[116:119], v45 offset:4624
  ds_read_b128 v[120:123], v45 offset:4640
  ds_read_b128 v[124:127], v45 offset:4656
  ds_read_b64 v[96:97], v13 offset:8192
  ds_read_b64 v[98:99], v13 offset:9216
  ds_read_b64 v[100:101], v13 offset:10240
  ds_read_b64 v[102:103], v13 offset:11264
  ds_read_b64 v[104:105], v13 offset:12288
  ds_read_b64 v[106:107], v13 offset:13312
  ds_read_b64 v[108:109], v13 offset:14336
  ds_read_b64 v[110:111], v13 offset:15360
  s_waitcnt lgkmcnt(8)
  v_pk_add_f32 v[112:113], v[112:113], v[114:115]
  v_pk_add_f32 v[116:117], v[116:117], v[118:119]
  v_pk_add_f32 v[120:121], v[120:121], v[122:123]
  v_pk_add_f32 v[124:125], v[124:125], v[126:127]
  v_pk_add_f32 v[112:113], v[112:113], v[116:117]
  v_pk_add_f32 v[120:121], v[120:121], v[124:125]
  v_pk_add_f32 v[112:113], v[112:113], v[120:121]
  v_mul_f32 v28, 0x3b000000, v112
  v_mul_f32 v29, 0x3b000000, v113
  v_fma_f32 v29, -v28, v28, v29
  v_max_f32 v29, 0, v29
  v_cvt_pk_bf16_f32 v10, v28, v29
  v_lshlrev_b32 v28, 16, v10
  v_and_b32 v29, 0xffff0000, v10
  v_add_f32 v29, 0x3727c5ac, v29
  v_cvt_pk_bf16_f32 v10, v29, v29
  v_and_b32 v29, 0xffff0000, v10
  v_sqrt_f32 v29, v29
  s_nop 0
  v_cvt_pk_bf16_f32 v10, v29, v29
  v_and_b32 v29, 0xffff0000, v10
  v_rcp_f32 v29, v29
  s_waitcnt lgkmcnt(0)
  v_pk_add_f32 v[96:97], v[96:97], v[98:99]
  v_pk_add_f32 v[100:101], v[100:101], v[102:103]
  v_pk_add_f32 v[104:105], v[104:105], v[106:107]
  v_pk_add_f32 v[108:109], v[108:109], v[110:111]
  v_pk_add_f32 v[96:97], v[96:97], v[100:101]
  v_pk_add_f32 v[104:105], v[104:105], v[108:109]
  v_pk_add_f32 v[22:23], v[96:97], v[104:105]
  v_fma_f32 v22, -v28, v50, v22
  v_fma_f32 v23, -v28, v51, v23
  v_fma_f32 v22, v22, v29, v52
  v_fma_f32 v23, v23, v29, v53
  v_cvt_pk_bf16_f32 v9, v22, v23
  v_lshlrev_b32 v22, 16, v9
  v_and_b32 v23, 0xffff0000, v9
  v_mul_f32 v9, 0xbfb8aa3b, v22
  v_mul_f32 v10, 0xbfb8aa3b, v23
  v_exp_f32 v9, v9
  v_exp_f32 v10, v10
  v_add_f32 v9, 1.0, v9
  v_add_f32 v10, 1.0, v10
  v_rcp_f32 v9, v9
  v_rcp_f32 v10, v10
  v_mul_f32 v22, v22, v9
  v_mul_f32 v23, v23, v10
  v_cvt_pk_bf16_f32 v22, v22, v23
  ds_write_b32 v14, v22 offset:0
  ds_read_b128 v[64:67], v15 offset:0
  ds_read_b128 v[68:71], v15 offset:16
  s_waitcnt lgkmcnt(0)
  v_mfma_f32_16x16x32_bf16 v[80:83], v[64:67], v[160:163], 0
  v_mfma_f32_16x16x32_bf16 v[84:87], v[64:67], v[164:167], 0
  v_mfma_f32_16x16x32_bf16 v[88:91], v[64:67], v[168:171], 0
  v_mfma_f32_16x16x32_bf16 v[92:95], v[64:67], v[172:175], 0
  v_mfma_f32_16x16x32_bf16 v[80:83], v[68:71], v[176:179], v[80:83]
  v_mfma_f32_16x16x32_bf16 v[84:87], v[68:71], v[180:183], v[84:87]
  v_mfma_f32_16x16x32_bf16 v[88:91], v[68:71], v[184:187], v[88:91]
  v_mfma_f32_16x16x32_bf16 v[92:95], v[68:71], v[188:191], v[92:95]
  v_mfma_f32_16x16x32_bf16 v[96:99], v[64:67], v[192:195], 0
  v_mfma_f32_16x16x32_bf16 v[100:103], v[64:67], v[196:199], 0
  v_mfma_f32_16x16x32_bf16 v[104:107], v[64:67], v[200:203], 0
  v_mfma_f32_16x16x32_bf16 v[108:111], v[64:67], v[204:207], 0
  s_nop 1
  v_cvt_pk_bf16_f32 v56, v80, v84
  s_nop 0
  v_cvt_pk_bf16_f32 v58, v88, v92
  s_mov_b32 exec_hi, 0
  buffer_store_dwordx4 v[56:59], v16, s[44:47], s7 offen offset:0 sc1
  s_mov_b32 exec_hi, -1
  v_mfma_f32_16x16x32_bf16 v[96:99], v[68:71], v[208:211], v[96:99]
  v_mfma_f32_16x16x32_bf16 v[100:103], v[68:71], v[212:215], v[100:103]
  v_mfma_f32_16x16x32_bf16 v[104:107], v[68:71], v[216:219], v[104:107]
  v_mfma_f32_16x16x32_bf16 v[108:111], v[68:71], v[220:223], v[108:111]
  s_nop 5
  v_cvt_pk_bf16_f32 v60, v96, v100
  s_nop 0
  v_cvt_pk_bf16_f32 v62, v104, v108
  s_mov_b32 exec_hi, 0
  buffer_store_dwordx4 v[60:63], v16, s[44:47], s7 offen offset:512 sc1
  s_mov_b32 exec_hi, -1
L_rdone:
L_end:
  s_endpgm
.section .rodata,"a"
.p2align 6
.amdhsa_kernel adaLN_cond__gqa_block_cached__dense_activation_silu__decode_kernel
  .amdhsa_next_free_vgpr 256
  .amdhsa_next_free_sgpr 102
  .amdhsa_accum_offset 256
  .amdhsa_group_segment_fixed_size 0
  .amdhsa_kernarg_size 104
  .amdhsa_user_sgpr_count 2
  .amdhsa_user_sgpr_kernarg_segment_ptr 1
  .amdhsa_system_sgpr_workgroup_id_x 1
.end_amdhsa_kernel
```
